```python
import torch

def _softmax(x, axis=-1):
    return torch.softmax(x, dim=axis)

def _gelu(x):
    return torch.nn.functional.gelu(x, approximate='tanh')

def _silu(x):
    return torch.nn.functional.silu(x)

def _sigmoid(x):
    return torch.sigmoid(x)

def _layernorm(x, axis=-1, eps=1e-05):
    m = x.mean(dim=axis, keepdim=True)
    v = x.var(dim=axis, keepdim=True, unbiased=False)
    return (x - m) / torch.sqrt(v + eps)

def _scatter_add(tgt, idx, src, axis=0):
    return tgt.clone().index_add_(axis, idx, src)

def _segment_sum(src, seg, n):
    out = torch.zeros((n,) + src.shape[1:], dtype=src.dtype)
    return out.index_add_(0, seg, src)

def _pad(x, pw):
    flat = tuple((v for pair in reversed(pw) for v in pair))
    return torch.nn.functional.pad(x, flat)
kernel_name = 'adaLN_cond__sliding_block__moe_arch_mod__prompt'

def setup_inputs():

    _w = lambda a: (lambda t: t.to(torch.bfloat16) if t.is_floating_point() else t)(torch.as_tensor(a))

    def _A_setup():
        B, S, D = (1, 2048, 512)
        return {'x': _w((lambda *s: torch.randn(*s, dtype=torch.bfloat16) * 0.05)(B, S, D)), 'wqkv': _w((lambda *s: torch.randn(*s, dtype=torch.bfloat16) * 0.05)(D, 3 * D)), 'wo': _w((lambda *s: torch.randn(*s, dtype=torch.bfloat16) * 0.2)(D, D))}
    _A_in = _A_setup()

    def _B_setup():
        B, S, D, F, C = (1, 2048, 512, 1376, 2)
        return {'x': _w((lambda *s: torch.randn(*s, dtype=torch.bfloat16) * 0.05)(B, S, D)), 'w_r': _w((lambda *s: torch.randn(*s, dtype=torch.bfloat16) * 3.2)(D)), 'w_gate': _w((lambda *s: torch.randn(*s, dtype=torch.bfloat16) * 0.1)(D, F)), 'w_up': _w((lambda *s: torch.randn(*s, dtype=torch.bfloat16) * 0.1)(D, F)), 'w_down': _w((lambda *s: torch.randn(*s, dtype=torch.bfloat16) * 0.1)(F, D))}
    _B_in = _B_setup()
    return {'A_x': _A_in['x'], 'A_wqkv': _A_in['wqkv'], 'A_wo': _A_in['wo'], 'B_x': _B_in['x'], 'B_w_r': _B_in['w_r'], 'B_w_gate': _B_in['w_gate'], 'B_w_up': _B_in['w_up'], 'B_w_down': _B_in['w_down'], 'c': _w((lambda *s: torch.randn(*s, dtype=torch.bfloat16) * 0.1)(1, 512) * 8.0), 'w_mod': _w((lambda *s: torch.randn(*s, dtype=torch.bfloat16) * 0.1)(512, 6 * 512) * 512 ** (-0.5) * 8.0)}

def reference(A_x, A_wqkv, A_wo, B_x, B_w_r, B_w_gate, B_w_up, B_w_down, c, w_mod):

    def _A_ref(x, wqkv, wo):
        B, S, D = x.shape
        H = 32
        Dh = D // H
        W = 256
        qkv = (lambda x, *d: x.permute(*d))((x @ wqkv).reshape(B, S, 3, H, Dh), 2, 0, 3, 1, 4)
        q, k, v = (qkv[0], qkv[1], qkv[2])
        scores = torch.einsum('bhqd,bhkd->bhqk', q, k) * Dh ** (-0.5)
        idx = torch.arange(S)
        mask = (idx[:, None] - idx[None, :] >= 0) & (idx[:, None] - idx[None, :] < W)
        scores = torch.where(mask[None, None], scores, -1000000000.0)
        p = _softmax(scores, axis=-1)
        o = torch.einsum('bhqk,bhkd->bhqd', p, v)
        return (lambda x, *d: x.permute(*d))(o, 0, 2, 1, 3).reshape(B, S, D) @ wo

    def _B_ref(x, w_r, w_gate, w_up, w_down):
        B, S, D = x.shape
        C = 2
        r = x @ w_r
        idx = torch.argsort(-r, axis=-1)[:, :C]
        idx_e = (lambda x, n, axis: torch.repeat_interleave(x, n, dim=axis))(idx.reshape(B, C, 1), D, axis=2)
        x_sel = (lambda x, i, axis: torch.take_along_dim(x, i, dim=axis))(x, idx_e, axis=1)
        g = _silu(x_sel @ w_gate)
        u = x_sel @ w_up
        y = g * u @ w_down
        r_sel = _sigmoid((lambda x, i, axis: torch.take_along_dim(x, i, dim=axis))(r, idx, axis=1))
        y = y * r_sel.reshape(B, C, 1)
        b_off = (torch.arange(B) * S).reshape(B, 1)
        flat_idx = (idx + b_off).reshape(B * C)
        zero = (x * 0.0).reshape(B * S, D)
        upd = _scatter_add(zero, flat_idx, y.reshape(B * C, D), axis=0)
        return x + upd.reshape(B, S, D)
    x = A_x
    mod = (_silu(c) @ w_mod).reshape(c.shape[0], 6, 1, -1)
    sa, ca, ga, sb, cb, gb = (mod[:, 0].clone(), mod[:, 1].clone(), mod[:, 2].clone(), mod[:, 3].clone(), mod[:, 4].clone(), mod[:, 5].clone())
    h = _layernorm(x, axis=-1) * (1 + ca) + sa
    x = x + ga * _A_ref(h, A_wqkv, A_wo)
    h = _layernorm(x, axis=-1) * (1 + cb) + sb
    x = x + gb * _B_ref(h, B_w_r, B_w_gate, B_w_up, B_w_down)
    return x
```

```asm
; @launch grid=(256,1,1) block=(512,1,1) lds=163840
.amdgcn_target "amdgcn-amd-amdhsa--gfx950"
.text
.globl adaLN_cond__sliding_block__moe_arch_mod__prompt_kernel
.p2align 8
.type adaLN_cond__sliding_block__moe_arch_mod__prompt_kernel,@function
adaLN_cond__sliding_block__moe_arch_mod__prompt_kernel:
    s_cmp_ge_u32 s2, 256
    s_cbranch_scc1 L_exit
    s_load_dwordx4 s[4:7], s[0:1], 0
    s_load_dwordx4 s[16:19], s[0:1], 56
    s_load_dwordx4 s[20:23], s[0:1], 72
    s_load_dwordx2 s[24:25], s[0:1], 96
    s_load_dwordx2 s[8:9], s[0:1], 16
    s_load_dwordx2 s[10:11], s[0:1], 32
    s_load_dwordx4 s[12:15], s[0:1], 40
    v_and_b32 v1, 63, v0
    v_lshrrev_b32 v2, 6, v0
    s_nop 0
    v_readfirstlane_b32 s29, v2
    s_bfe_u32 s32, s2, 0x20001
    s_lshl_b32 s27, s32, 2
    s_lshr_b32 s33, s2, 6
    s_add_u32 s27, s27, s33
    s_and_b32 s32, s2, 1
    s_lshl_b32 s28, s32, 3
    s_bfe_u32 s33, s2, 0x30003
    s_add_u32 s28, s28, s33
    s_and_b32 s30, s29, 3
    s_lshr_b32 s31, s29, 2
    v_lshlrev_b32 v14, 4, v1
    v_lshrrev_b32 v15, 2, v1
    s_movk_i32 s32, 3072
    v_mul_lo_u32 v150, v15, s32
    v_and_b32 v15, 3, v1
    v_lshlrev_b32 v15, 4, v15
    v_add_u32 v150, v150, v15
    s_waitcnt lgkmcnt(0)
    s_load_dword s44, s[24:25], 0
    s_cmp_ge_u32 s29, 4
    s_cbranch_scc1 L_rx
    s_cmp_eq_u32 s29, 0
    s_cbranch_scc1 L_r0
    s_cmp_eq_u32 s29, 1
    s_cbranch_scc1 L_r1
    s_sub_u32 s40, s29, 2
    s_lshl_b32 s41, s40, 4
    s_mul_i32 s32, s41, 49152
    s_lshl_b32 s33, s28, 6
    s_add_u32 s32, s32, s33
    s_add_u32 s38, s6, s32
    s_addc_u32 s39, s7, 0
    s_mul_i32 s32, s40, 12288
    s_add_u32 m0, s32, 139264
    s_nop 0
    global_load_lds_dwordx4 v150, s[38:39] offset:0
    global_load_lds_dwordx4 v150, s[38:39] offset:1024
    global_load_lds_dwordx4 v150, s[38:39] offset:2048
    s_add_u32 s38, s38, 49152
    s_addc_u32 s39, s39, 0
    s_add_u32 m0, m0, 3072
    s_nop 0
    global_load_lds_dwordx4 v150, s[38:39] offset:0
    global_load_lds_dwordx4 v150, s[38:39] offset:1024
    global_load_lds_dwordx4 v150, s[38:39] offset:2048
    s_add_u32 s38, s38, 49152
    s_addc_u32 s39, s39, 0
    s_add_u32 m0, m0, 3072
    s_nop 0
    global_load_lds_dwordx4 v150, s[38:39] offset:0
    global_load_lds_dwordx4 v150, s[38:39] offset:1024
    global_load_lds_dwordx4 v150, s[38:39] offset:2048
    s_cmp_eq_u32 s29, 2
    s_cbranch_scc0 L_rdone
    s_add_u32 s38, s38, 49152
    s_addc_u32 s39, s39, 0
    s_add_u32 m0, m0, 3072
    s_nop 0
    global_load_lds_dwordx4 v150, s[38:39] offset:0
    global_load_lds_dwordx4 v150, s[38:39] offset:1024
    global_load_lds_dwordx4 v150, s[38:39] offset:2048
    s_branch L_rdone
L_r1:
    s_cmp_lt_u32 s2, 128
    s_cbranch_scc1 L_rdone
    s_bfe_u32 s40, s2, 0x10006
    s_lshl_b32 s32, s40, 8
    s_add_u32 s32, s32, 64
    s_mul_i32 s32, s32, 3072
    s_lshl_b32 s33, s28, 6
    s_add_u32 s32, s32, s33
    s_add_u32 s38, s6, s32
    s_addc_u32 s39, s7, 0
    s_movk_i32 s32, 3072
    v_mul_lo_u32 v4, v1, s32
    global_load_dword v136, v4, s[38:39] offset:0
    global_load_dword v137, v4, s[38:39] offset:1024
    global_load_dword v138, v4, s[38:39] offset:2048
    s_add_u32 s38, s38, 196608
    s_addc_u32 s39, s39, 0
    global_load_dword v139, v4, s[38:39] offset:0
    global_load_dword v140, v4, s[38:39] offset:1024
    global_load_dword v141, v4, s[38:39] offset:2048
    s_add_u32 s38, s38, 196608
    s_addc_u32 s39, s39, 0
    global_load_dword v142, v4, s[38:39] offset:0
    global_load_dword v143, v4, s[38:39] offset:1024
    global_load_dword v144, v4, s[38:39] offset:2048
    s_branch L_rdone
L_r0:
    s_cmp_lt_u32 s2, 128
    s_cbranch_scc0 L_r0b
    s_and_b32 s40, s2, 7
    s_lshl_b32 s40, s40, 6
    s_bfe_u32 s41, s2, 0x30003
    s_lshl_b32 s41, s41, 3
    s_add_u32 s40, s40, s41
    s_lshr_b32 s41, s2, 6
    s_lshl_b32 s42, s41, 9
    s_add_u32 s40, s40, s42
    s_lshl_b32 s42, s40, 1
    global_load_dwordx4 v[4:7], v14, s[18:19]
    s_movk_i32 s32, 6144
    v_mul_lo_u32 v9, v1, s32
    s_add_u32 s34, s20, s42
    s_addc_u32 s35, s21, 0
    s_mov_b32 m0, 0
    s_nop 0
    global_load_lds_dwordx4 v9, s[34:35]
    s_add_u32 s34, s34, 393216
    s_addc_u32 s35, s35, 0
    s_add_u32 m0, m0, 1024
    s_nop 0
    global_load_lds_dwordx4 v9, s[34:35]
    s_add_u32 s34, s34, 393216
    s_addc_u32 s35, s35, 0
    s_add_u32 m0, m0, 1024
    s_nop 0
    global_load_lds_dwordx4 v9, s[34:35]
    s_add_u32 s34, s34, 393216
    s_addc_u32 s35, s35, 0
    s_add_u32 m0, m0, 1024
    s_nop 0
    global_load_lds_dwordx4 v9, s[34:35]
    s_add_u32 s34, s34, 393216
    s_addc_u32 s35, s35, 0
    s_add_u32 m0, m0, 1024
    s_nop 0
    global_load_lds_dwordx4 v9, s[34:35]
    s_add_u32 s34, s34, 393216
    s_addc_u32 s35, s35, 0
    s_add_u32 m0, m0, 1024
    s_nop 0
    global_load_lds_dwordx4 v9, s[34:35]
    s_add_u32 s34, s34, 393216
    s_addc_u32 s35, s35, 0
    s_add_u32 m0, m0, 1024
    s_nop 0
    global_load_lds_dwordx4 v9, s[34:35]
    s_add_u32 s34, s34, 393216
    s_addc_u32 s35, s35, 0
    s_add_u32 m0, m0, 1024
    s_nop 0
    global_load_lds_dwordx4 v9, s[34:35]
    s_waitcnt vmcnt(8)
    v_lshlrev_b32 v16, 16, v4
    v_and_b32 v17, 0xffff0000, v4
    v_lshlrev_b32 v18, 16, v5
    v_and_b32 v19, 0xffff0000, v5
    v_lshlrev_b32 v20, 16, v6
    v_and_b32 v21, 0xffff0000, v6
    v_lshlrev_b32 v22, 16, v7
    v_and_b32 v23, 0xffff0000, v7
    v_mul_f32 v24, 0xbfb8aa3b, v16
    v_mul_f32 v25, 0xbfb8aa3b, v17
    v_mul_f32 v26, 0xbfb8aa3b, v18
    v_mul_f32 v27, 0xbfb8aa3b, v19
    v_mul_f32 v28, 0xbfb8aa3b, v20
    v_mul_f32 v29, 0xbfb8aa3b, v21
    v_mul_f32 v30, 0xbfb8aa3b, v22
    v_mul_f32 v31, 0xbfb8aa3b, v23
    v_exp_f32 v24, v24
    v_exp_f32 v25, v25
    v_exp_f32 v26, v26
    v_exp_f32 v27, v27
    v_exp_f32 v28, v28
    v_exp_f32 v29, v29
    v_exp_f32 v30, v30
    v_exp_f32 v31, v31
    v_add_f32 v24, 1.0, v24
    v_add_f32 v25, 1.0, v25
    v_add_f32 v26, 1.0, v26
    v_add_f32 v27, 1.0, v27
    v_add_f32 v28, 1.0, v28
    v_add_f32 v29, 1.0, v29
    v_add_f32 v30, 1.0, v30
    v_add_f32 v31, 1.0, v31
    v_rcp_f32 v24, v24
    v_rcp_f32 v25, v25
    v_rcp_f32 v26, v26
    v_rcp_f32 v27, v27
    v_rcp_f32 v28, v28
    v_rcp_f32 v29, v29
    v_rcp_f32 v30, v30
    v_rcp_f32 v31, v31
    v_mul_f32 v16, v16, v24
    v_mul_f32 v17, v17, v25
    v_mul_f32 v18, v18, v26
    v_mul_f32 v19, v19, v27
    v_mul_f32 v20, v20, v28
    v_mul_f32 v21, v21, v29
    v_mul_f32 v22, v22, v30
    v_mul_f32 v23, v23, v31
    v_cvt_pk_bf16_f32 v4, v16, v17
    v_cvt_pk_bf16_f32 v5, v18, v19
    v_cvt_pk_bf16_f32 v6, v20, v21
    v_cvt_pk_bf16_f32 v7, v22, v23
    v_add_u32 v10, 160768, v14
    ds_write_b128 v10, v[4:7]
    v_lshrrev_b32 v10, 4, v1
    v_lshlrev_b32 v11, 4, v10
    v_add_u32 v11, 160768, v11
    v_lshlrev_b32 v10, 7, v10
    v_bfe_u32 v12, v1, 2, 2
    v_lshlrev_b32 v12, 4, v12
    v_add_u32 v10, v10, v12
    v_and_b32 v12, 1, v1
    v_lshlrev_b32 v12, 3, v12
    v_add_u32 v10, v10, v12
    v_add_u32 v10, 0, v10
    v_mov_b32 v144, 0
    v_mov_b32 v145, 0
    v_mov_b32 v146, 0
    v_mov_b32 v147, 0
    s_waitcnt lgkmcnt(0)
    ds_read_b128 v[16:19], v11 offset:0
    ds_read_b128 v[20:23], v11 offset:64
    ds_read_b128 v[24:27], v11 offset:128
    ds_read_b128 v[28:31], v11 offset:192
    ds_read_b128 v[32:35], v11 offset:256
    ds_read_b128 v[36:39], v11 offset:320
    ds_read_b128 v[40:43], v11 offset:384
    ds_read_b128 v[44:47], v11 offset:448
    ds_read_b128 v[48:51], v11 offset:512
    ds_read_b128 v[52:55], v11 offset:576
    ds_read_b128 v[56:59], v11 offset:640
    ds_read_b128 v[60:63], v11 offset:704
    s_waitcnt lgkmcnt(4)
    ds_read_b128 v[64:67], v11 offset:768
    ds_read_b128 v[68:71], v11 offset:832
    ds_read_b128 v[72:75], v11 offset:896
    ds_read_b128 v[76:79], v11 offset:960
    s_waitcnt vmcnt(0) lgkmcnt(0)
    ds_read_b64_tr_b16 v[80:81], v10 offset:0
    ds_read_b64_tr_b16 v[82:83], v10 offset:64
    ds_read_b64_tr_b16 v[84:85], v10 offset:512
    ds_read_b64_tr_b16 v[86:87], v10 offset:576
    ds_read_b64_tr_b16 v[88:89], v10 offset:1024
    ds_read_b64_tr_b16 v[90:91], v10 offset:1088
    ds_read_b64_tr_b16 v[92:93], v10 offset:1536
    ds_read_b64_tr_b16 v[94:95], v10 offset:1600
    ds_read_b64_tr_b16 v[96:97], v10 offset:2048
    ds_read_b64_tr_b16 v[98:99], v10 offset:2112
    ds_read_b64_tr_b16 v[100:101], v10 offset:2560
    ds_read_b64_tr_b16 v[102:103], v10 offset:2624
    ds_read_b64_tr_b16 v[104:105], v10 offset:3072
    ds_read_b64_tr_b16 v[106:107], v10 offset:3136
    ds_read_b64_tr_b16 v[108:109], v10 offset:3584
    ds_read_b64_tr_b16 v[110:111], v10 offset:3648
    s_waitcnt lgkmcnt(8)
    v_mfma_f32_16x16x32_bf16 v[144:147], v[16:19], v[80:83], v[144:147]
    v_mfma_f32_16x16x32_bf16 v[144:147], v[20:23], v[84:87], v[144:147]
    v_mfma_f32_16x16x32_bf16 v[144:147], v[24:27], v[88:91], v[144:147]
    v_mfma_f32_16x16x32_bf16 v[144:147], v[28:31], v[92:95], v[144:147]
    ds_read_b64_tr_b16 v[112:113], v10 offset:4096
    ds_read_b64_tr_b16 v[114:115], v10 offset:4160
    ds_read_b64_tr_b16 v[116:117], v10 offset:4608
    ds_read_b64_tr_b16 v[118:119], v10 offset:4672
    ds_read_b64_tr_b16 v[120:121], v10 offset:5120
    ds_read_b64_tr_b16 v[122:123], v10 offset:5184
    ds_read_b64_tr_b16 v[124:125], v10 offset:5632
    ds_read_b64_tr_b16 v[126:127], v10 offset:5696
    s_waitcnt lgkmcnt(8)
    v_mfma_f32_16x16x32_bf16 v[144:147], v[32:35], v[96:99], v[144:147]
    v_mfma_f32_16x16x32_bf16 v[144:147], v[36:39], v[100:103], v[144:147]
    v_mfma_f32_16x16x32_bf16 v[144:147], v[40:43], v[104:107], v[144:147]
    v_mfma_f32_16x16x32_bf16 v[144:147], v[44:47], v[108:111], v[144:147]
    ds_read_b64_tr_b16 v[128:129], v10 offset:6144
    ds_read_b64_tr_b16 v[130:131], v10 offset:6208
    ds_read_b64_tr_b16 v[132:133], v10 offset:6656
    ds_read_b64_tr_b16 v[134:135], v10 offset:6720
    ds_read_b64_tr_b16 v[136:137], v10 offset:7168
    ds_read_b64_tr_b16 v[138:139], v10 offset:7232
    ds_read_b64_tr_b16 v[140:141], v10 offset:7680
    ds_read_b64_tr_b16 v[142:143], v10 offset:7744
    s_waitcnt lgkmcnt(8)
    v_mfma_f32_16x16x32_bf16 v[144:147], v[48:51], v[112:115], v[144:147]
    v_mfma_f32_16x16x32_bf16 v[144:147], v[52:55], v[116:119], v[144:147]
    v_mfma_f32_16x16x32_bf16 v[144:147], v[56:59], v[120:123], v[144:147]
    v_mfma_f32_16x16x32_bf16 v[144:147], v[60:63], v[124:127], v[144:147]
    s_waitcnt lgkmcnt(0)
    v_mfma_f32_16x16x32_bf16 v[144:147], v[64:67], v[128:131], v[144:147]
    v_mfma_f32_16x16x32_bf16 v[144:147], v[68:71], v[132:135], v[144:147]
    v_mfma_f32_16x16x32_bf16 v[144:147], v[72:75], v[136:139], v[144:147]
    v_mfma_f32_16x16x32_bf16 v[144:147], v[76:79], v[140:143], v[144:147]
    s_nop 7
    s_nop 1
    v_mov_b32 v8, v144
    s_waitcnt lgkmcnt(0)
    s_mul_i32 s26, s44, 0x9E3779B1
    s_add_u32 s26, s26, 0x7F4A7C15
    v_cvt_pk_bf16_f32 v8, v8, v8
    v_and_b32 v8, 0xffff0000, v8
    s_cmp_eq_u32 s41, 1
    s_cselect_b32 s32, 1.0, 0
    v_add_f32 v8, s32, v8
    s_nop 1
    v_mov_b32_dpp v9, v8 quad_perm:[1,1,3,3] row_mask:0xf bank_mask:0xf
    v_cvt_pk_bf16_f32 v8, v8, v9
    v_mov_b32 v9, s26
    v_add_u32 v4, s40, v1
    v_lshlrev_b32 v4, 2, v4
    v_add_u32 v4, 4096, v4
    s_mov_b64 exec, 0x55
    global_store_dwordx2 v4, v[8:9], s[24:25] sc1
    s_mov_b64 exec, -1
L_r0b:
    s_movk_i32 s41, 19
    s_mul_i32 s32, s41, 49152
    s_lshl_b32 s33, s28, 6
    s_add_u32 s32, s32, s33
    s_add_u32 s38, s6, s32
    s_addc_u32 s39, s7, 0
    s_mov_b32 m0, 160768
    s_nop 0
    global_load_lds_dwordx4 v150, s[38:39] offset:0
    global_load_lds_dwordx4 v150, s[38:39] offset:1024
    global_load_lds_dwordx4 v150, s[38:39] offset:2048
    s_branch L_rdone
L_rx:
    s_lshl_b32 s32, s27, 17
    s_lshl_b32 s33, s30, 15
    s_add_u32 s32, s32, s33
    s_add_u32 s36, s4, s32
    s_addc_u32 s37, s5, 0
    s_add_u32 s34, s33, 8192
    s_and_b32 s35, s28, 7
    s_lshl_b32 s35, s35, 2
    s_lshl_b32 s32, s35, 10
    s_add_u32 m0, s32, s34
    s_and_b32 s33, s35, 15
    s_lshl_b32 s33, s33, 4
    s_or_b32 s32, s32, s33
    v_xor_b32 v15, s32, v14
    global_load_lds_dwordx4 v15, s[36:37]
    s_add_u32 s35, s35, 1
    s_and_b32 s35, s35, 31
    s_lshl_b32 s32, s35, 10
    s_add_u32 m0, s32, s34
    s_and_b32 s33, s35, 15
    s_lshl_b32 s33, s33, 4
    s_or_b32 s32, s32, s33
    v_xor_b32 v15, s32, v14
    global_load_lds_dwordx4 v15, s[36:37]
    s_add_u32 s35, s35, 1
    s_and_b32 s35, s35, 31
    s_lshl_b32 s32, s35, 10
    s_add_u32 m0, s32, s34
    s_and_b32 s33, s35, 15
    s_lshl_b32 s33, s33, 4
    s_or_b32 s32, s32, s33
    v_xor_b32 v15, s32, v14
    global_load_lds_dwordx4 v15, s[36:37]
    s_add_u32 s35, s35, 1
    s_and_b32 s35, s35, 31
    s_lshl_b32 s32, s35, 10
    s_add_u32 m0, s32, s34
    s_and_b32 s33, s35, 15
    s_lshl_b32 s33, s33, 4
    s_or_b32 s32, s32, s33
    v_xor_b32 v15, s32, v14
    global_load_lds_dwordx4 v15, s[36:37]
    s_add_u32 s35, s35, 1
    s_and_b32 s35, s35, 31
    s_lshl_b32 s32, s35, 10
    s_add_u32 m0, s32, s34
    s_and_b32 s33, s35, 15
    s_lshl_b32 s33, s33, 4
    s_or_b32 s32, s32, s33
    v_xor_b32 v15, s32, v14
    global_load_lds_dwordx4 v15, s[36:37]
    s_add_u32 s35, s35, 1
    s_and_b32 s35, s35, 31
    s_lshl_b32 s32, s35, 10
    s_add_u32 m0, s32, s34
    s_and_b32 s33, s35, 15
    s_lshl_b32 s33, s33, 4
    s_or_b32 s32, s32, s33
    v_xor_b32 v15, s32, v14
    global_load_lds_dwordx4 v15, s[36:37]
    s_add_u32 s35, s35, 1
    s_and_b32 s35, s35, 31
    s_lshl_b32 s32, s35, 10
    s_add_u32 m0, s32, s34
    s_and_b32 s33, s35, 15
    s_lshl_b32 s33, s33, 4
    s_or_b32 s32, s32, s33
    v_xor_b32 v15, s32, v14
    global_load_lds_dwordx4 v15, s[36:37]
    s_add_u32 s35, s35, 1
    s_and_b32 s35, s35, 31
    s_lshl_b32 s32, s35, 10
    s_add_u32 m0, s32, s34
    s_and_b32 s33, s35, 15
    s_lshl_b32 s33, s33, 4
    s_or_b32 s32, s32, s33
    v_xor_b32 v15, s32, v14
    global_load_lds_dwordx4 v15, s[36:37]
    s_add_u32 s35, s35, 1
    s_and_b32 s35, s35, 31
    s_lshl_b32 s32, s35, 10
    s_add_u32 m0, s32, s34
    s_and_b32 s33, s35, 15
    s_lshl_b32 s33, s33, 4
    s_or_b32 s32, s32, s33
    v_xor_b32 v15, s32, v14
    global_load_lds_dwordx4 v15, s[36:37]
    s_add_u32 s35, s35, 1
    s_and_b32 s35, s35, 31
    s_lshl_b32 s32, s35, 10
    s_add_u32 m0, s32, s34
    s_and_b32 s33, s35, 15
    s_lshl_b32 s33, s33, 4
    s_or_b32 s32, s32, s33
    v_xor_b32 v15, s32, v14
    global_load_lds_dwordx4 v15, s[36:37]
    s_add_u32 s35, s35, 1
    s_and_b32 s35, s35, 31
    s_lshl_b32 s32, s35, 10
    s_add_u32 m0, s32, s34
    s_and_b32 s33, s35, 15
    s_lshl_b32 s33, s33, 4
    s_or_b32 s32, s32, s33
    v_xor_b32 v15, s32, v14
    global_load_lds_dwordx4 v15, s[36:37]
    s_add_u32 s35, s35, 1
    s_and_b32 s35, s35, 31
    s_lshl_b32 s32, s35, 10
    s_add_u32 m0, s32, s34
    s_and_b32 s33, s35, 15
    s_lshl_b32 s33, s33, 4
    s_or_b32 s32, s32, s33
    v_xor_b32 v15, s32, v14
    global_load_lds_dwordx4 v15, s[36:37]
    s_add_u32 s35, s35, 1
    s_and_b32 s35, s35, 31
    s_lshl_b32 s32, s35, 10
    s_add_u32 m0, s32, s34
    s_and_b32 s33, s35, 15
    s_lshl_b32 s33, s33, 4
    s_or_b32 s32, s32, s33
    v_xor_b32 v15, s32, v14
    global_load_lds_dwordx4 v15, s[36:37]
    s_add_u32 s35, s35, 1
    s_and_b32 s35, s35, 31
    s_lshl_b32 s32, s35, 10
    s_add_u32 m0, s32, s34
    s_and_b32 s33, s35, 15
    s_lshl_b32 s33, s33, 4
    s_or_b32 s32, s32, s33
    v_xor_b32 v15, s32, v14
    global_load_lds_dwordx4 v15, s[36:37]
    s_add_u32 s35, s35, 1
    s_and_b32 s35, s35, 31
    s_lshl_b32 s32, s35, 10
    s_add_u32 m0, s32, s34
    s_and_b32 s33, s35, 15
    s_lshl_b32 s33, s33, 4
    s_or_b32 s32, s32, s33
    v_xor_b32 v15, s32, v14
    global_load_lds_dwordx4 v15, s[36:37]
    s_add_u32 s35, s35, 1
    s_and_b32 s35, s35, 31
    s_lshl_b32 s32, s35, 10
    s_add_u32 m0, s32, s34
    s_and_b32 s33, s35, 15
    s_lshl_b32 s33, s33, 4
    s_or_b32 s32, s32, s33
    v_xor_b32 v15, s32, v14
    global_load_lds_dwordx4 v15, s[36:37]
    s_add_u32 s35, s35, 1
    s_and_b32 s35, s35, 31
    s_lshl_b32 s32, s35, 10
    s_add_u32 m0, s32, s34
    s_and_b32 s33, s35, 15
    s_lshl_b32 s33, s33, 4
    s_or_b32 s32, s32, s33
    v_xor_b32 v15, s32, v14
    global_load_lds_dwordx4 v15, s[36:37]
    s_add_u32 s35, s35, 1
    s_and_b32 s35, s35, 31
    s_lshl_b32 s32, s35, 10
    s_add_u32 m0, s32, s34
    s_and_b32 s33, s35, 15
    s_lshl_b32 s33, s33, 4
    s_or_b32 s32, s32, s33
    v_xor_b32 v15, s32, v14
    global_load_lds_dwordx4 v15, s[36:37]
    s_add_u32 s35, s35, 1
    s_and_b32 s35, s35, 31
    s_lshl_b32 s32, s35, 10
    s_add_u32 m0, s32, s34
    s_and_b32 s33, s35, 15
    s_lshl_b32 s33, s33, 4
    s_or_b32 s32, s32, s33
    v_xor_b32 v15, s32, v14
    global_load_lds_dwordx4 v15, s[36:37]
    s_add_u32 s35, s35, 1
    s_and_b32 s35, s35, 31
    s_lshl_b32 s32, s35, 10
    s_add_u32 m0, s32, s34
    s_and_b32 s33, s35, 15
    s_lshl_b32 s33, s33, 4
    s_or_b32 s32, s32, s33
    v_xor_b32 v15, s32, v14
    global_load_lds_dwordx4 v15, s[36:37]
    s_add_u32 s35, s35, 1
    s_and_b32 s35, s35, 31
    s_lshl_b32 s32, s35, 10
    s_add_u32 m0, s32, s34
    s_and_b32 s33, s35, 15
    s_lshl_b32 s33, s33, 4
    s_or_b32 s32, s32, s33
    v_xor_b32 v15, s32, v14
    global_load_lds_dwordx4 v15, s[36:37]
    s_add_u32 s35, s35, 1
    s_and_b32 s35, s35, 31
    s_lshl_b32 s32, s35, 10
    s_add_u32 m0, s32, s34
    s_and_b32 s33, s35, 15
    s_lshl_b32 s33, s33, 4
    s_or_b32 s32, s32, s33
    v_xor_b32 v15, s32, v14
    global_load_lds_dwordx4 v15, s[36:37]
    s_add_u32 s35, s35, 1
    s_and_b32 s35, s35, 31
    s_lshl_b32 s32, s35, 10
    s_add_u32 m0, s32, s34
    s_and_b32 s33, s35, 15
    s_lshl_b32 s33, s33, 4
    s_or_b32 s32, s32, s33
    v_xor_b32 v15, s32, v14
    global_load_lds_dwordx4 v15, s[36:37]
    s_add_u32 s35, s35, 1
    s_and_b32 s35, s35, 31
    s_lshl_b32 s32, s35, 10
    s_add_u32 m0, s32, s34
    s_and_b32 s33, s35, 15
    s_lshl_b32 s33, s33, 4
    s_or_b32 s32, s32, s33
    v_xor_b32 v15, s32, v14
    global_load_lds_dwordx4 v15, s[36:37]
    s_add_u32 s35, s35, 1
    s_and_b32 s35, s35, 31
    s_lshl_b32 s32, s35, 10
    s_add_u32 m0, s32, s34
    s_and_b32 s33, s35, 15
    s_lshl_b32 s33, s33, 4
    s_or_b32 s32, s32, s33
    v_xor_b32 v15, s32, v14
    global_load_lds_dwordx4 v15, s[36:37]
    s_add_u32 s35, s35, 1
    s_and_b32 s35, s35, 31
    s_lshl_b32 s32, s35, 10
    s_add_u32 m0, s32, s34
    s_and_b32 s33, s35, 15
    s_lshl_b32 s33, s33, 4
    s_or_b32 s32, s32, s33
    v_xor_b32 v15, s32, v14
    global_load_lds_dwordx4 v15, s[36:37]
    s_add_u32 s35, s35, 1
    s_and_b32 s35, s35, 31
    s_lshl_b32 s32, s35, 10
    s_add_u32 m0, s32, s34
    s_and_b32 s33, s35, 15
    s_lshl_b32 s33, s33, 4
    s_or_b32 s32, s32, s33
    v_xor_b32 v15, s32, v14
    global_load_lds_dwordx4 v15, s[36:37]
    s_add_u32 s35, s35, 1
    s_and_b32 s35, s35, 31
    s_lshl_b32 s32, s35, 10
    s_add_u32 m0, s32, s34
    s_and_b32 s33, s35, 15
    s_lshl_b32 s33, s33, 4
    s_or_b32 s32, s32, s33
    v_xor_b32 v15, s32, v14
    global_load_lds_dwordx4 v15, s[36:37]
    s_add_u32 s35, s35, 1
    s_and_b32 s35, s35, 31
    s_lshl_b32 s32, s35, 10
    s_add_u32 m0, s32, s34
    s_and_b32 s33, s35, 15
    s_lshl_b32 s33, s33, 4
    s_or_b32 s32, s32, s33
    v_xor_b32 v15, s32, v14
    global_load_lds_dwordx4 v15, s[36:37]
    s_add_u32 s35, s35, 1
    s_and_b32 s35, s35, 31
    s_lshl_b32 s32, s35, 10
    s_add_u32 m0, s32, s34
    s_and_b32 s33, s35, 15
    s_lshl_b32 s33, s33, 4
    s_or_b32 s32, s32, s33
    v_xor_b32 v15, s32, v14
    global_load_lds_dwordx4 v15, s[36:37]
    s_add_u32 s35, s35, 1
    s_and_b32 s35, s35, 31
    s_lshl_b32 s32, s35, 10
    s_add_u32 m0, s32, s34
    s_and_b32 s33, s35, 15
    s_lshl_b32 s33, s33, 4
    s_or_b32 s32, s32, s33
    v_xor_b32 v15, s32, v14
    global_load_lds_dwordx4 v15, s[36:37]
    s_add_u32 s35, s35, 1
    s_and_b32 s35, s35, 31
    s_lshl_b32 s32, s35, 10
    s_add_u32 m0, s32, s34
    s_and_b32 s33, s35, 15
    s_lshl_b32 s33, s33, 4
    s_or_b32 s32, s32, s33
    v_xor_b32 v15, s32, v14
    global_load_lds_dwordx4 v15, s[36:37]
    s_waitcnt vmcnt(0)
L_rdone:
    s_waitcnt lgkmcnt(0)
    s_mul_i32 s26, s44, 0x9E3779B1
    s_add_u32 s26, s26, 0x7F4A7C15
    v_and_b32 v2, 31, v1
    s_lshl_b32 s32, s30, 5
    v_add_u32 v2, s32, v2
    v_lshlrev_b32 v2, 10, v2
    v_lshrrev_b32 v3, 5, v1
    v_and_b32 v4, 15, v1
    v_xor_b32 v4, v4, v3
    v_lshlrev_b32 v4, 4, v4
    s_lshl_b32 s32, s31, 9
    v_add_u32 v2, v2, v4
    v_add_u32 v2, s32, v2
    v_xor_b32 v113, 0, v2
    v_xor_b32 v114, 32, v2
    v_xor_b32 v115, 64, v2
    v_xor_b32 v116, 96, v2
    v_xor_b32 v117, 128, v2
    v_xor_b32 v118, 160, v2
    v_xor_b32 v119, 192, v2
    v_xor_b32 v120, 224, v2
    s_lshl_b32 s32, s28, 3
    s_add_u32 s40, s32, s29
    s_lshl_b32 s32, s40, 10
    v_add_u32 v6, s32, v14
    s_barrier
    ds_read_b128 v[8:11], v6 offset:8192
    ds_read_b128 v[192:195], v113 offset:8192
    ds_read_b128 v[196:199], v114 offset:8192
    ds_read_b128 v[200:203], v115 offset:8192
    ds_read_b128 v[204:207], v116 offset:8192
    ds_read_b128 v[208:211], v117 offset:8192
    ds_read_b128 v[212:215], v118 offset:8192
    ds_read_b128 v[216:219], v119 offset:8192
    ds_read_b128 v[220:223], v120 offset:8192
    ds_read_b128 v[224:227], v113 offset:8448
    ds_read_b128 v[228:231], v114 offset:8448
    ds_read_b128 v[232:235], v115 offset:8448
    ds_read_b128 v[236:239], v116 offset:8448
    ds_read_b128 v[240:243], v117 offset:8448
    ds_read_b128 v[244:247], v118 offset:8448
    s_waitcnt lgkmcnt(13)
    ds_read_b128 v[248:251], v119 offset:8448
    ds_read_b128 v[252:255], v120 offset:8448
    v_lshlrev_b32 v6, 3, v0
    v_add_u32 v6, 4096, v6
    s_cmp_lt_u32 s29, 4
    s_cbranch_scc0 L_nomp
    global_load_dwordx2 v[20:21], v6, s[24:25] sc1
    global_load_dwordx2 v[22:23], v6, s[24:25] offset:2048 sc1
L_nomp:
    v_mov_b32 v3, 0x3f803f80
    v_dot2_f32_bf16 v4, v8, v3, 0
    v_dot2_f32_bf16 v5, v8, v8, 0
    v_dot2_f32_bf16 v4, v9, v3, v4
    v_dot2_f32_bf16 v5, v9, v9, v5
    v_dot2_f32_bf16 v4, v10, v3, v4
    v_dot2_f32_bf16 v5, v10, v10, v5
    v_dot2_f32_bf16 v4, v11, v3, v4
    v_dot2_f32_bf16 v5, v11, v11, v5
    s_nop 1
    s_nop 1
    v_add_f32_dpp v4, v4, v4 quad_perm:[1,0,3,2] row_mask:0xf bank_mask:0xf
    v_add_f32_dpp v5, v5, v5 quad_perm:[1,0,3,2] row_mask:0xf bank_mask:0xf
    s_nop 1
    v_add_f32_dpp v4, v4, v4 quad_perm:[2,3,0,1] row_mask:0xf bank_mask:0xf
    v_add_f32_dpp v5, v5, v5 quad_perm:[2,3,0,1] row_mask:0xf bank_mask:0xf
    s_nop 1
    v_add_f32_dpp v4, v4, v4 row_half_mirror row_mask:0xf bank_mask:0xf
    v_add_f32_dpp v5, v5, v5 row_half_mirror row_mask:0xf bank_mask:0xf
    s_nop 1
    v_add_f32_dpp v4, v4, v4 row_mirror row_mask:0xf bank_mask:0xf
    v_add_f32_dpp v5, v5, v5 row_mirror row_mask:0xf bank_mask:0xf
    s_nop 0
    v_mov_b32 v8, v4
    v_mov_b32 v9, v5
    s_nop 1
    v_permlane16_swap_b32 v4, v8
    v_permlane16_swap_b32 v5, v9
    s_nop 1
    v_add_f32 v4, v4, v8
    v_add_f32 v5, v5, v9
    s_nop 0
    v_mov_b32 v8, v4
    v_mov_b32 v9, v5
    s_nop 1
    v_permlane32_swap_b32 v4, v8
    v_permlane32_swap_b32 v5, v9
    s_nop 1
    v_add_f32 v4, v4, v8
    v_add_f32 v5, v5, v9
    v_mul_f32 v4, 0x3b000000, v4
    v_mul_f32 v5, 0x3b000000, v5
    v_fma_f32 v5, -v4, v4, v5
    v_max_f32 v5, 0, v5
    v_add_f32 v5, 0x3727c5ac, v5
    v_rsq_f32 v9, v5
    s_nop 0
    v_mul_f32 v8, v4, v9
    v_sub_f32 v8, 0, v8
    v_mov_b32 v10, s26
    v_mov_b32 v11, s26
    s_lshl_b32 s32, s27, 7
    s_add_u32 s32, s32, s40
    s_lshl_b32 s32, s32, 4
    s_add_u32 s32, s32, 786432
    v_mov_b32 v7, s32
    s_mov_b64 exec, 1
    global_store_dwordx4 v7, v[8:11], s[24:25] sc1
    s_mov_b64 exec, -1
    s_waitcnt lgkmcnt(0)
    s_barrier
    s_cmp_lt_u32 s29, 4
    s_cbranch_scc1 L_mp
    s_add_u32 s41, s30, 4
    s_mul_i32 s32, s41, 49152
    s_lshl_b32 s33, s28, 6
    s_add_u32 s32, s32, s33
    s_add_u32 s38, s6, s32
    s_addc_u32 s39, s7, 0
    s_mul_i32 s32, s30, 3072
    s_add_u32 m0, s32, 8192
    s_nop 0
    global_load_lds_dwordx4 v150, s[38:39] offset:0
    global_load_lds_dwordx4 v150, s[38:39] offset:1024
    global_load_lds_dwordx4 v150, s[38:39] offset:2048
    s_add_u32 s41, s30, 20
    s_mul_i32 s32, s41, 49152
    s_lshl_b32 s33, s28, 6
    s_add_u32 s32, s32, s33
    s_add_u32 s38, s6, s32
    s_addc_u32 s39, s7, 0
    s_mul_i32 s32, s30, 3072
    s_add_u32 m0, s32, 45056
    s_nop 0
    global_load_lds_dwordx4 v150, s[38:39] offset:0
    global_load_lds_dwordx4 v150, s[38:39] offset:1024
    global_load_lds_dwordx4 v150, s[38:39] offset:2048
    s_cmp_eq_u32 s29, 4
    s_cbranch_scc0 L_mpd
    s_and_b32 s32, s27, 3
    s_lshl_b32 s32, s32, 1
    s_bfe_u32 s33, s28, 0x10002
    s_add_u32 s32, s32, s33
    s_lshl_b32 s32, s32, 16
    s_and_b32 s33, s28, 3
    s_lshl_b32 s33, s33, 8
    s_add_u32 s32, s32, s33
    s_add_u32 s38, s8, s32
    s_addc_u32 s39, s9, 0
    v_lshlrev_b32 v4, 10, v1
    global_load_dword v176, v4, s[38:39]
    global_load_dword v177, v4, s[38:39] offset:128
    s_and_b32 s32, s2, 7
    s_lshl_b32 s32, s32, 9
    s_lshr_b32 s33, s2, 6
    s_lshl_b32 s33, s33, 7
    s_add_u32 s32, s32, s33
    s_bfe_u32 s33, s2, 0x30003
    s_mul_i32 s33, s33, 393216
    s_add_u32 s32, s32, s33
    s_add_u32 s32, s32, 2048
    s_add_u32 s38, s20, s32
    s_addc_u32 s39, s21, 0
    s_movk_i32 s32, 6144
    v_mul_lo_u32 v4, v1, s32
    global_load_dword v178, v4, s[38:39]
    s_branch L_mpd
L_mp:
    s_waitcnt vmcnt(1)
    v_cmp_ne_u32 vcc, s26, v21
    v_cmp_ne_u32 s[34:35], s26, v23
    s_or_b64 vcc, vcc, s[34:35]
    s_cbranch_vccz L_mpok
    s_mov_b32 s64, 200000
L_poll_1:
    global_load_dwordx2 v[20:21], v6, s[24:25] sc1
    global_load_dwordx2 v[22:23], v6, s[24:25] offset:2048 sc1
    s_waitcnt vmcnt(0)
    v_cmp_ne_u32 vcc, s26, v21
    v_cmp_ne_u32 s[66:67], s26, v23
    s_or_b64 vcc, vcc, s[66:67]
    s_cbranch_vccz L_polld_2
    s_sub_u32 s64, s64, 1
    s_cbranch_scc0 L_poll_1
L_polld_2:
L_mpok:
    v_lshlrev_b32 v6, 2, v0
    ds_write_b32 v6, v20 offset:3072
    ds_write_b32 v6, v22 offset:2048
    v_lshlrev_b32 v24, 16, v22
    v_and_b32 v25, 0xffff0000, v22
    v_lshlrev_b32 v7, 3, v0
    ds_write_b64 v7, v[24:25] offset:0
    v_mov_b32 v8, 0
    v_and_b32 v6, 0x1fc, v6
    ds_write_b32 v6, v8 offset:4096
L_mpd:
    v_lshrrev_b32 v6, 5, v1
    v_lshlrev_b32 v7, 9, v6
    v_bfe_u32 v8, v1, 2, 2
    v_lshlrev_b32 v8, 6, v8
    v_add_u32 v7, v7, v8
    v_bfe_u32 v8, v1, 4, 1
    v_lshlrev_b32 v8, 5, v8
    v_add_u32 v7, v7, v8
    v_and_b32 v8, 3, v1
    v_lshlrev_b32 v8, 3, v8
    v_add_u32 v7, v7, v8
    s_mul_i32 s32, s31, 12288
    s_add_u32 s32, s32, 139264
    v_add_u32 v12, s32, v7
    s_mul_i32 s32, s31, 36864
    s_add_u32 s32, s32, 8192
    v_add_u32 v13, s32, v7
    v_lshlrev_b32 v14, 5, v6
    s_lshl_b32 s32, s31, 10
    s_add_u32 s32, s32, 0
    v_add_u32 v14, s32, v14
    v_and_b32 v6, 15, v1
    v_lshrrev_b32 v7, 4, v1
    v_lshrrev_b32 v8, 1, v6
    v_lshlrev_b32 v8, 10, v8
    v_lshrrev_b32 v9, 1, v7
    v_lshlrev_b32 v9, 4, v9
    v_add_u32 v8, v8, v9
    s_lshl_b32 s32, s31, 9
    s_add_u32 s32, s32, 2048
    v_add_u32 v8, s32, v8
    v_xor_b32 v7, v6, v7
    v_and_b32 v7, 1, v7
    v_cmp_eq_u32 vcc, 0, v7
    v_cmp_gt_u32 s[34:35], 4, v6
    s_and_b64 vcc, vcc, s[34:35]
    v_mov_b32 v9, 4096
    v_cndmask_b32 v15, v9, v8, vcc
    s_lshl_b32 s41, s31, 4
    s_add_u32 s41, s41, s30
    s_add_u32 s41, s41, 8
    s_mul_i32 s32, s41, 49152
    s_lshl_b32 s33, s28, 6
    s_add_u32 s32, s32, s33
    s_add_u32 s38, s6, s32
    s_addc_u32 s39, s7, 0
    s_mul_i32 s42, s31, 36864
    s_mul_i32 s32, s30, 3072
    s_add_u32 s42, s42, s32
    s_add_u32 s42, s42, 20480
    s_mov_b32 m0, s42
    v_and_b32 v6, 31, v1
    s_lshl_b32 s32, s27, 7
    s_lshl_b32 s33, s30, 5
    s_add_u32 s32, s32, s33
    v_add_u32 v6, s32, v6
    v_lshlrev_b32 v6, 4, v6
    v_add_u32 v11, 786432, v6
    v_mov_b32 v16, 0
    v_mov_b32 v17, 0
    v_mov_b32 v18, 0
    v_mov_b32 v19, 0
    v_mov_b32 v20, 0
    v_mov_b32 v21, 0
    v_mov_b32 v22, 0
    v_mov_b32 v23, 0
    v_mov_b32 v24, 0
    v_mov_b32 v25, 0
    v_mov_b32 v26, 0
    v_mov_b32 v27, 0
    v_mov_b32 v28, 0
    v_mov_b32 v29, 0
    v_mov_b32 v30, 0
    v_mov_b32 v31, 0
    v_mov_b32 v32, 0
    v_mov_b32 v33, 0
    v_mov_b32 v34, 0
    v_mov_b32 v35, 0
    v_mov_b32 v36, 0
    v_mov_b32 v37, 0
    v_mov_b32 v38, 0
    v_mov_b32 v39, 0
    v_mov_b32 v40, 0
    v_mov_b32 v41, 0
    v_mov_b32 v42, 0
    v_mov_b32 v43, 0
    v_mov_b32 v44, 0
    v_mov_b32 v45, 0
    v_mov_b32 v46, 0
    v_mov_b32 v47, 0
    v_mov_b32 v48, 0
    v_mov_b32 v49, 0
    v_mov_b32 v50, 0
    v_mov_b32 v51, 0
    v_mov_b32 v52, 0
    v_mov_b32 v53, 0
    v_mov_b32 v54, 0
    v_mov_b32 v55, 0
    v_mov_b32 v56, 0
    v_mov_b32 v57, 0
    v_mov_b32 v58, 0
    v_mov_b32 v59, 0
    v_mov_b32 v60, 0
    v_mov_b32 v61, 0
    v_mov_b32 v62, 0
    v_mov_b32 v63, 0
    v_mov_b32 v64, 0
    v_mov_b32 v65, 0
    v_mov_b32 v66, 0
    v_mov_b32 v67, 0
    s_waitcnt lgkmcnt(0)
    s_barrier
    s_cmp_eq_u32 s30, 0
    s_cbranch_scc0 L_lpv1
    ds_read_b128 v[104:107], v14 offset:0
    ds_read_b128 v[108:111], v14 offset:16
    ds_read_b64_tr_b16 v[80:81], v12 offset:0
    ds_read_b64_tr_b16 v[82:83], v12 offset:256
    ds_read_b64_tr_b16 v[84:85], v12 offset:1024
    ds_read_b64_tr_b16 v[86:87], v12 offset:1280
    ds_read_b64_tr_b16 v[88:89], v12 offset:2048
    ds_read_b64_tr_b16 v[90:91], v12 offset:2304
    ds_read_b128 v[112:115], v14 offset:64
    ds_read_b128 v[116:119], v14 offset:80
    ds_read_b128 v[120:123], v15 offset:0
    s_waitcnt lgkmcnt(9)
    v_lshlrev_b32 v136, 16, v192
    v_and_b32 v137, 0xffff0000, v192
    v_mul_f32 v136, v136, v104
    v_mul_f32 v137, v137, v105
    v_cvt_pk_bf16_f32 v128, v136, v137
    v_lshlrev_b32 v138, 16, v193
    v_and_b32 v139, 0xffff0000, v193
    v_mul_f32 v138, v138, v106
    v_mul_f32 v139, v139, v107
    v_cvt_pk_bf16_f32 v129, v138, v139
    v_lshlrev_b32 v140, 16, v194
    v_and_b32 v141, 0xffff0000, v194
    v_mul_f32 v140, v140, v108
    v_mul_f32 v141, v141, v109
    v_cvt_pk_bf16_f32 v130, v140, v141
    v_lshlrev_b32 v142, 16, v195
    v_and_b32 v143, 0xffff0000, v195
    v_mul_f32 v142, v142, v110
    v_mul_f32 v143, v143, v111
    v_cvt_pk_bf16_f32 v131, v142, v143
    s_waitcnt lgkmcnt(0)
    ds_read_b64_tr_b16 v[92:93], v12 offset:3072
    ds_read_b64_tr_b16 v[94:95], v12 offset:3328
    ds_read_b64_tr_b16 v[96:97], v12 offset:4096
    ds_read_b64_tr_b16 v[98:99], v12 offset:4352
    ds_read_b64_tr_b16 v[100:101], v12 offset:5120
    ds_read_b64_tr_b16 v[102:103], v12 offset:5376
    ds_read_b128 v[124:127], v15 offset:32
    ds_read_b128 v[104:107], v14 offset:128
    ds_read_b128 v[108:111], v14 offset:144
    s_nop 1
    v_mfma_f32_32x32x16_bf16 v[16:31], v[80:83], v[128:131], v[16:31]
    v_lshlrev_b32 v136, 16, v196
    v_and_b32 v137, 0xffff0000, v196
    v_mul_f32 v136, v136, v112
    v_mul_f32 v137, v137, v113
    v_cvt_pk_bf16_f32 v132, v136, v137
    v_lshlrev_b32 v138, 16, v197
    v_and_b32 v139, 0xffff0000, v197
    v_mfma_f32_32x32x16_bf16 v[32:47], v[84:87], v[128:131], v[32:47]
    global_load_lds_dwordx4 v150, s[38:39] offset:0
    v_mul_f32 v138, v138, v114
    v_mul_f32 v139, v139, v115
    v_cvt_pk_bf16_f32 v133, v138, v139
    v_lshlrev_b32 v140, 16, v198
    v_and_b32 v141, 0xffff0000, v198
    v_mul_f32 v140, v140, v116
    v_mul_f32 v141, v141, v117
    v_mfma_f32_32x32x16_bf16 v[48:63], v[128:131], v[88:91], v[48:63]
    v_cvt_pk_bf16_f32 v134, v140, v141
    v_lshlrev_b32 v142, 16, v199
    v_and_b32 v143, 0xffff0000, v199
    v_mul_f32 v142, v142, v118
    v_mul_f32 v143, v143, v119
    v_cvt_pk_bf16_f32 v135, v142, v143
    v_mfma_f32_16x16x32_bf16 v[64:67], v[80:83], v[120:123], v[64:67]
    s_waitcnt lgkmcnt(0)
    ds_read_b64_tr_b16 v[80:81], v12 offset:6144
    ds_read_b64_tr_b16 v[82:83], v12 offset:6400
    ds_read_b64_tr_b16 v[84:85], v12 offset:7168
    ds_read_b64_tr_b16 v[86:87], v12 offset:7424
    ds_read_b64_tr_b16 v[88:89], v12 offset:8192
    ds_read_b64_tr_b16 v[90:91], v12 offset:8448
    ds_read_b128 v[120:123], v15 offset:64
    ds_read_b128 v[112:115], v14 offset:192
    ds_read_b128 v[116:119], v14 offset:208
    v_mfma_f32_32x32x16_bf16 v[16:31], v[92:95], v[132:135], v[16:31]
    v_lshlrev_b32 v136, 16, v200
    v_and_b32 v137, 0xffff0000, v200
    v_mul_f32 v136, v136, v104
    v_mul_f32 v137, v137, v105
    v_cvt_pk_bf16_f32 v128, v136, v137
    v_lshlrev_b32 v138, 16, v201
    v_and_b32 v139, 0xffff0000, v201
    v_mfma_f32_32x32x16_bf16 v[32:47], v[96:99], v[132:135], v[32:47]
    global_load_lds_dwordx4 v150, s[38:39] offset:1024
    v_mul_f32 v138, v138, v106
    v_mul_f32 v139, v139, v107
    v_cvt_pk_bf16_f32 v129, v138, v139
    v_lshlrev_b32 v140, 16, v202
    v_and_b32 v141, 0xffff0000, v202
    v_mul_f32 v140, v140, v108
    v_mul_f32 v141, v141, v109
    v_mfma_f32_32x32x16_bf16 v[48:63], v[132:135], v[100:103], v[48:63]
    v_cvt_pk_bf16_f32 v130, v140, v141
    v_lshlrev_b32 v142, 16, v203
    v_and_b32 v143, 0xffff0000, v203
    v_mul_f32 v142, v142, v110
    v_mul_f32 v143, v143, v111
    v_cvt_pk_bf16_f32 v131, v142, v143
    v_mfma_f32_16x16x32_bf16 v[64:67], v[92:95], v[124:127], v[64:67]
    s_waitcnt lgkmcnt(0)
    ds_read_b64_tr_b16 v[92:93], v12 offset:9216
    ds_read_b64_tr_b16 v[94:95], v12 offset:9472
    ds_read_b64_tr_b16 v[96:97], v12 offset:10240
    ds_read_b64_tr_b16 v[98:99], v12 offset:10496
    ds_read_b64_tr_b16 v[100:101], v12 offset:11264
    ds_read_b64_tr_b16 v[102:103], v12 offset:11520
    ds_read_b128 v[124:127], v15 offset:96
    ds_read_b128 v[104:107], v14 offset:256
    ds_read_b128 v[108:111], v14 offset:272
    v_mfma_f32_32x32x16_bf16 v[16:31], v[80:83], v[128:131], v[16:31]
    v_lshlrev_b32 v136, 16, v204
    v_and_b32 v137, 0xffff0000, v204
    v_mul_f32 v136, v136, v112
    v_mul_f32 v137, v137, v113
    v_cvt_pk_bf16_f32 v132, v136, v137
    v_lshlrev_b32 v138, 16, v205
    v_and_b32 v139, 0xffff0000, v205
    v_mfma_f32_32x32x16_bf16 v[32:47], v[84:87], v[128:131], v[32:47]
    global_load_lds_dwordx4 v150, s[38:39] offset:2048
    v_mul_f32 v138, v138, v114
    v_mul_f32 v139, v139, v115
    v_cvt_pk_bf16_f32 v133, v138, v139
    v_lshlrev_b32 v140, 16, v206
    v_and_b32 v141, 0xffff0000, v206
    v_mul_f32 v140, v140, v116
    v_mul_f32 v141, v141, v117
    v_mfma_f32_32x32x16_bf16 v[48:63], v[128:131], v[88:91], v[48:63]
    v_cvt_pk_bf16_f32 v134, v140, v141
    v_lshlrev_b32 v142, 16, v207
    v_and_b32 v143, 0xffff0000, v207
    v_mul_f32 v142, v142, v118
    v_mul_f32 v143, v143, v119
    v_cvt_pk_bf16_f32 v135, v142, v143
    v_mfma_f32_16x16x32_bf16 v[64:67], v[80:83], v[120:123], v[64:67]
    s_waitcnt lgkmcnt(0)
    s_waitcnt vmcnt(3)
    s_barrier
    ds_read_b64_tr_b16 v[80:81], v13 offset:0
    ds_read_b64_tr_b16 v[82:83], v13 offset:256
    ds_read_b64_tr_b16 v[84:85], v13 offset:1024
    ds_read_b64_tr_b16 v[86:87], v13 offset:1280
    ds_read_b64_tr_b16 v[88:89], v13 offset:2048
    ds_read_b64_tr_b16 v[90:91], v13 offset:2304
    ds_read_b128 v[120:123], v15 offset:128
    ds_read_b128 v[112:115], v14 offset:320
    ds_read_b128 v[116:119], v14 offset:336
    v_mfma_f32_32x32x16_bf16 v[16:31], v[92:95], v[132:135], v[16:31]
    v_lshlrev_b32 v136, 16, v208
    v_and_b32 v137, 0xffff0000, v208
    v_mul_f32 v136, v136, v104
    v_mul_f32 v137, v137, v105
    v_cvt_pk_bf16_f32 v128, v136, v137
    v_lshlrev_b32 v138, 16, v209
    v_and_b32 v139, 0xffff0000, v209
    v_mfma_f32_32x32x16_bf16 v[32:47], v[96:99], v[132:135], v[32:47]
    s_add_u32 s38, s38, 196608
    s_addc_u32 s39, s39, 0
    s_add_u32 m0, m0, 12288
    s_nop 0
    global_load_lds_dwordx4 v150, s[38:39] offset:0
    v_mul_f32 v138, v138, v106
    v_mul_f32 v139, v139, v107
    v_cvt_pk_bf16_f32 v129, v138, v139
    v_lshlrev_b32 v140, 16, v210
    v_and_b32 v141, 0xffff0000, v210
    v_mul_f32 v140, v140, v108
    v_mul_f32 v141, v141, v109
    v_mfma_f32_32x32x16_bf16 v[48:63], v[132:135], v[100:103], v[48:63]
    v_cvt_pk_bf16_f32 v130, v140, v141
    v_lshlrev_b32 v142, 16, v211
    v_and_b32 v143, 0xffff0000, v211
    v_mul_f32 v142, v142, v110
    v_mul_f32 v143, v143, v111
    v_cvt_pk_bf16_f32 v131, v142, v143
    v_mfma_f32_16x16x32_bf16 v[64:67], v[92:95], v[124:127], v[64:67]
    s_waitcnt lgkmcnt(0)
    ds_read_b64_tr_b16 v[92:93], v13 offset:3072
    ds_read_b64_tr_b16 v[94:95], v13 offset:3328
    ds_read_b64_tr_b16 v[96:97], v13 offset:4096
    ds_read_b64_tr_b16 v[98:99], v13 offset:4352
    ds_read_b64_tr_b16 v[100:101], v13 offset:5120
    ds_read_b64_tr_b16 v[102:103], v13 offset:5376
    ds_read_b128 v[124:127], v15 offset:160
    ds_read_b128 v[104:107], v14 offset:384
    ds_read_b128 v[108:111], v14 offset:400
    v_mfma_f32_32x32x16_bf16 v[16:31], v[80:83], v[128:131], v[16:31]
    v_lshlrev_b32 v136, 16, v212
    v_and_b32 v137, 0xffff0000, v212
    v_mul_f32 v136, v136, v112
    v_mul_f32 v137, v137, v113
    v_cvt_pk_bf16_f32 v132, v136, v137
    v_lshlrev_b32 v138, 16, v213
    v_and_b32 v139, 0xffff0000, v213
    v_mfma_f32_32x32x16_bf16 v[32:47], v[84:87], v[128:131], v[32:47]
    global_load_lds_dwordx4 v150, s[38:39] offset:1024
    v_mul_f32 v138, v138, v114
    v_mul_f32 v139, v139, v115
    v_cvt_pk_bf16_f32 v133, v138, v139
    v_lshlrev_b32 v140, 16, v214
    v_and_b32 v141, 0xffff0000, v214
    v_mul_f32 v140, v140, v116
    v_mul_f32 v141, v141, v117
    v_mfma_f32_32x32x16_bf16 v[48:63], v[128:131], v[88:91], v[48:63]
    v_cvt_pk_bf16_f32 v134, v140, v141
    v_lshlrev_b32 v142, 16, v215
    v_and_b32 v143, 0xffff0000, v215
    v_mul_f32 v142, v142, v118
    v_mul_f32 v143, v143, v119
    v_cvt_pk_bf16_f32 v135, v142, v143
    v_mfma_f32_16x16x32_bf16 v[64:67], v[80:83], v[120:123], v[64:67]
    s_waitcnt lgkmcnt(0)
    ds_read_b64_tr_b16 v[80:81], v13 offset:6144
    ds_read_b64_tr_b16 v[82:83], v13 offset:6400
    ds_read_b64_tr_b16 v[84:85], v13 offset:7168
    ds_read_b64_tr_b16 v[86:87], v13 offset:7424
    ds_read_b64_tr_b16 v[88:89], v13 offset:8192
    ds_read_b64_tr_b16 v[90:91], v13 offset:8448
    ds_read_b128 v[120:123], v15 offset:192
    ds_read_b128 v[112:115], v14 offset:448
    ds_read_b128 v[116:119], v14 offset:464
    v_mfma_f32_32x32x16_bf16 v[16:31], v[92:95], v[132:135], v[16:31]
    v_lshlrev_b32 v136, 16, v216
    v_and_b32 v137, 0xffff0000, v216
    v_mul_f32 v136, v136, v104
    v_mul_f32 v137, v137, v105
    v_cvt_pk_bf16_f32 v128, v136, v137
    v_lshlrev_b32 v138, 16, v217
    v_and_b32 v139, 0xffff0000, v217
    v_mfma_f32_32x32x16_bf16 v[32:47], v[96:99], v[132:135], v[32:47]
    global_load_lds_dwordx4 v150, s[38:39] offset:2048
    v_mul_f32 v138, v138, v106
    v_mul_f32 v139, v139, v107
    v_cvt_pk_bf16_f32 v129, v138, v139
    v_lshlrev_b32 v140, 16, v218
    v_and_b32 v141, 0xffff0000, v218
    v_mul_f32 v140, v140, v108
    v_mul_f32 v141, v141, v109
    v_mfma_f32_32x32x16_bf16 v[48:63], v[132:135], v[100:103], v[48:63]
    v_cvt_pk_bf16_f32 v130, v140, v141
    v_lshlrev_b32 v142, 16, v219
    v_and_b32 v143, 0xffff0000, v219
    v_mul_f32 v142, v142, v110
    v_mul_f32 v143, v143, v111
    v_cvt_pk_bf16_f32 v131, v142, v143
    v_mfma_f32_16x16x32_bf16 v[64:67], v[92:95], v[124:127], v[64:67]
    s_waitcnt lgkmcnt(0)
    ds_read_b64_tr_b16 v[92:93], v13 offset:9216
    ds_read_b64_tr_b16 v[94:95], v13 offset:9472
    ds_read_b64_tr_b16 v[96:97], v13 offset:10240
    ds_read_b64_tr_b16 v[98:99], v13 offset:10496
    ds_read_b64_tr_b16 v[100:101], v13 offset:11264
    ds_read_b64_tr_b16 v[102:103], v13 offset:11520
    ds_read_b128 v[124:127], v15 offset:224
    ds_read_b128 v[104:107], v14 offset:512
    ds_read_b128 v[108:111], v14 offset:528
    v_mfma_f32_32x32x16_bf16 v[16:31], v[80:83], v[128:131], v[16:31]
    v_lshlrev_b32 v136, 16, v220
    v_and_b32 v137, 0xffff0000, v220
    v_mul_f32 v136, v136, v112
    v_mul_f32 v137, v137, v113
    v_cvt_pk_bf16_f32 v132, v136, v137
    v_lshlrev_b32 v138, 16, v221
    v_and_b32 v139, 0xffff0000, v221
    v_mfma_f32_32x32x16_bf16 v[32:47], v[84:87], v[128:131], v[32:47]
    v_mul_f32 v138, v138, v114
    v_mul_f32 v139, v139, v115
    v_cvt_pk_bf16_f32 v133, v138, v139
    v_lshlrev_b32 v140, 16, v222
    v_and_b32 v141, 0xffff0000, v222
    v_mul_f32 v140, v140, v116
    v_mul_f32 v141, v141, v117
    v_mfma_f32_32x32x16_bf16 v[48:63], v[128:131], v[88:91], v[48:63]
    v_cvt_pk_bf16_f32 v134, v140, v141
    v_lshlrev_b32 v142, 16, v223
    v_and_b32 v143, 0xffff0000, v223
    v_mul_f32 v142, v142, v118
    v_mul_f32 v143, v143, v119
    v_cvt_pk_bf16_f32 v135, v142, v143
    v_mfma_f32_16x16x32_bf16 v[64:67], v[80:83], v[120:123], v[64:67]
    s_waitcnt lgkmcnt(0)
    s_waitcnt vmcnt(3)
    s_barrier
    ds_read_b64_tr_b16 v[80:81], v13 offset:12288
    ds_read_b64_tr_b16 v[82:83], v13 offset:12544
    ds_read_b64_tr_b16 v[84:85], v13 offset:13312
    ds_read_b64_tr_b16 v[86:87], v13 offset:13568
    ds_read_b64_tr_b16 v[88:89], v13 offset:14336
    ds_read_b64_tr_b16 v[90:91], v13 offset:14592
    ds_read_b128 v[120:123], v15 offset:256
    ds_read_b128 v[112:115], v14 offset:576
    ds_read_b128 v[116:119], v14 offset:592
    v_mfma_f32_32x32x16_bf16 v[16:31], v[92:95], v[132:135], v[16:31]
    v_lshlrev_b32 v136, 16, v224
    v_and_b32 v137, 0xffff0000, v224
    v_mul_f32 v136, v136, v104
    v_mul_f32 v137, v137, v105
    v_cvt_pk_bf16_f32 v128, v136, v137
    v_lshlrev_b32 v138, 16, v225
    v_and_b32 v139, 0xffff0000, v225
    v_mfma_f32_32x32x16_bf16 v[32:47], v[96:99], v[132:135], v[32:47]
    v_mul_f32 v138, v138, v106
    v_mul_f32 v139, v139, v107
    v_cvt_pk_bf16_f32 v129, v138, v139
    v_lshlrev_b32 v140, 16, v226
    v_and_b32 v141, 0xffff0000, v226
    v_mul_f32 v140, v140, v108
    v_mul_f32 v141, v141, v109
    v_mfma_f32_32x32x16_bf16 v[48:63], v[132:135], v[100:103], v[48:63]
    v_cvt_pk_bf16_f32 v130, v140, v141
    v_lshlrev_b32 v142, 16, v227
    v_and_b32 v143, 0xffff0000, v227
    v_mul_f32 v142, v142, v110
    v_mul_f32 v143, v143, v111
    v_cvt_pk_bf16_f32 v131, v142, v143
    v_mfma_f32_16x16x32_bf16 v[64:67], v[92:95], v[124:127], v[64:67]
    s_waitcnt lgkmcnt(0)
    ds_read_b64_tr_b16 v[92:93], v13 offset:15360
    ds_read_b64_tr_b16 v[94:95], v13 offset:15616
    ds_read_b64_tr_b16 v[96:97], v13 offset:16384
    ds_read_b64_tr_b16 v[98:99], v13 offset:16640
    ds_read_b64_tr_b16 v[100:101], v13 offset:17408
    ds_read_b64_tr_b16 v[102:103], v13 offset:17664
    ds_read_b128 v[124:127], v15 offset:288
    ds_read_b128 v[104:107], v14 offset:640
    ds_read_b128 v[108:111], v14 offset:656
    v_mfma_f32_32x32x16_bf16 v[16:31], v[80:83], v[128:131], v[16:31]
    v_lshlrev_b32 v136, 16, v228
    v_and_b32 v137, 0xffff0000, v228
    v_mul_f32 v136, v136, v112
    v_mul_f32 v137, v137, v113
    v_cvt_pk_bf16_f32 v132, v136, v137
    v_lshlrev_b32 v138, 16, v229
    v_and_b32 v139, 0xffff0000, v229
    v_mfma_f32_32x32x16_bf16 v[32:47], v[84:87], v[128:131], v[32:47]
    v_mul_f32 v138, v138, v114
    v_mul_f32 v139, v139, v115
    v_cvt_pk_bf16_f32 v133, v138, v139
    v_lshlrev_b32 v140, 16, v230
    v_and_b32 v141, 0xffff0000, v230
    v_mul_f32 v140, v140, v116
    v_mul_f32 v141, v141, v117
    v_mfma_f32_32x32x16_bf16 v[48:63], v[128:131], v[88:91], v[48:63]
    v_cvt_pk_bf16_f32 v134, v140, v141
    v_lshlrev_b32 v142, 16, v231
    v_and_b32 v143, 0xffff0000, v231
    v_mul_f32 v142, v142, v118
    v_mul_f32 v143, v143, v119
    v_cvt_pk_bf16_f32 v135, v142, v143
    v_mfma_f32_16x16x32_bf16 v[64:67], v[80:83], v[120:123], v[64:67]
    s_waitcnt lgkmcnt(0)
    ds_read_b64_tr_b16 v[80:81], v13 offset:18432
    ds_read_b64_tr_b16 v[82:83], v13 offset:18688
    ds_read_b64_tr_b16 v[84:85], v13 offset:19456
    ds_read_b64_tr_b16 v[86:87], v13 offset:19712
    ds_read_b64_tr_b16 v[88:89], v13 offset:20480
    ds_read_b64_tr_b16 v[90:91], v13 offset:20736
    ds_read_b128 v[120:123], v15 offset:320
    ds_read_b128 v[112:115], v14 offset:704
    ds_read_b128 v[116:119], v14 offset:720
    v_mfma_f32_32x32x16_bf16 v[16:31], v[92:95], v[132:135], v[16:31]
    v_lshlrev_b32 v136, 16, v232
    v_and_b32 v137, 0xffff0000, v232
    v_mul_f32 v136, v136, v104
    v_mul_f32 v137, v137, v105
    v_cvt_pk_bf16_f32 v128, v136, v137
    v_lshlrev_b32 v138, 16, v233
    v_and_b32 v139, 0xffff0000, v233
    v_mfma_f32_32x32x16_bf16 v[32:47], v[96:99], v[132:135], v[32:47]
    v_mul_f32 v138, v138, v106
    v_mul_f32 v139, v139, v107
    v_cvt_pk_bf16_f32 v129, v138, v139
    v_lshlrev_b32 v140, 16, v234
    v_and_b32 v141, 0xffff0000, v234
    v_mul_f32 v140, v140, v108
    v_mul_f32 v141, v141, v109
    v_mfma_f32_32x32x16_bf16 v[48:63], v[132:135], v[100:103], v[48:63]
    v_cvt_pk_bf16_f32 v130, v140, v141
    v_lshlrev_b32 v142, 16, v235
    v_and_b32 v143, 0xffff0000, v235
    v_mul_f32 v142, v142, v110
    v_mul_f32 v143, v143, v111
    v_cvt_pk_bf16_f32 v131, v142, v143
    v_mfma_f32_16x16x32_bf16 v[64:67], v[92:95], v[124:127], v[64:67]
    s_waitcnt lgkmcnt(0)
    ds_read_b64_tr_b16 v[92:93], v13 offset:21504
    ds_read_b64_tr_b16 v[94:95], v13 offset:21760
    ds_read_b64_tr_b16 v[96:97], v13 offset:22528
    ds_read_b64_tr_b16 v[98:99], v13 offset:22784
    ds_read_b64_tr_b16 v[100:101], v13 offset:23552
    ds_read_b64_tr_b16 v[102:103], v13 offset:23808
    ds_read_b128 v[124:127], v15 offset:352
    ds_read_b128 v[104:107], v14 offset:768
    ds_read_b128 v[108:111], v14 offset:784
    v_mfma_f32_32x32x16_bf16 v[16:31], v[80:83], v[128:131], v[16:31]
    v_lshlrev_b32 v136, 16, v236
    v_and_b32 v137, 0xffff0000, v236
    v_mul_f32 v136, v136, v112
    v_mul_f32 v137, v137, v113
    v_cvt_pk_bf16_f32 v132, v136, v137
    v_lshlrev_b32 v138, 16, v237
    v_and_b32 v139, 0xffff0000, v237
    v_mfma_f32_32x32x16_bf16 v[32:47], v[84:87], v[128:131], v[32:47]
    v_mul_f32 v138, v138, v114
    v_mul_f32 v139, v139, v115
    v_cvt_pk_bf16_f32 v133, v138, v139
    v_lshlrev_b32 v140, 16, v238
    v_and_b32 v141, 0xffff0000, v238
    v_mul_f32 v140, v140, v116
    v_mul_f32 v141, v141, v117
    v_mfma_f32_32x32x16_bf16 v[48:63], v[128:131], v[88:91], v[48:63]
    v_cvt_pk_bf16_f32 v134, v140, v141
    v_lshlrev_b32 v142, 16, v239
    v_and_b32 v143, 0xffff0000, v239
    v_mul_f32 v142, v142, v118
    v_mul_f32 v143, v143, v119
    v_cvt_pk_bf16_f32 v135, v142, v143
    v_mfma_f32_16x16x32_bf16 v[64:67], v[80:83], v[120:123], v[64:67]
    s_waitcnt lgkmcnt(0)
    s_waitcnt vmcnt(0)
    s_barrier
    global_load_dwordx4 v[4:7], v11, s[24:25] sc1
    ds_read_b64_tr_b16 v[80:81], v13 offset:24576
    ds_read_b64_tr_b16 v[82:83], v13 offset:24832
    ds_read_b64_tr_b16 v[84:85], v13 offset:25600
    ds_read_b64_tr_b16 v[86:87], v13 offset:25856
    ds_read_b64_tr_b16 v[88:89], v13 offset:26624
    ds_read_b64_tr_b16 v[90:91], v13 offset:26880
    ds_read_b128 v[120:123], v15 offset:384
    ds_read_b128 v[112:115], v14 offset:832
    ds_read_b128 v[116:119], v14 offset:848
    v_mfma_f32_32x32x16_bf16 v[16:31], v[92:95], v[132:135], v[16:31]
    v_lshlrev_b32 v136, 16, v240
    v_and_b32 v137, 0xffff0000, v240
    v_mul_f32 v136, v136, v104
    v_mul_f32 v137, v137, v105
    v_cvt_pk_bf16_f32 v128, v136, v137
    v_lshlrev_b32 v138, 16, v241
    v_and_b32 v139, 0xffff0000, v241
    v_mfma_f32_32x32x16_bf16 v[32:47], v[96:99], v[132:135], v[32:47]
    v_mul_f32 v138, v138, v106
    v_mul_f32 v139, v139, v107
    v_cvt_pk_bf16_f32 v129, v138, v139
    v_lshlrev_b32 v140, 16, v242
    v_and_b32 v141, 0xffff0000, v242
    v_mul_f32 v140, v140, v108
    v_mul_f32 v141, v141, v109
    v_mfma_f32_32x32x16_bf16 v[48:63], v[132:135], v[100:103], v[48:63]
    v_cvt_pk_bf16_f32 v130, v140, v141
    v_lshlrev_b32 v142, 16, v243
    v_and_b32 v143, 0xffff0000, v243
    v_mul_f32 v142, v142, v110
    v_mul_f32 v143, v143, v111
    v_cvt_pk_bf16_f32 v131, v142, v143
    v_mfma_f32_16x16x32_bf16 v[64:67], v[92:95], v[124:127], v[64:67]
    s_waitcnt lgkmcnt(0)
    ds_read_b64_tr_b16 v[92:93], v13 offset:27648
    ds_read_b64_tr_b16 v[94:95], v13 offset:27904
    ds_read_b64_tr_b16 v[96:97], v13 offset:28672
    ds_read_b64_tr_b16 v[98:99], v13 offset:28928
    ds_read_b64_tr_b16 v[100:101], v13 offset:29696
    ds_read_b64_tr_b16 v[102:103], v13 offset:29952
    ds_read_b128 v[124:127], v15 offset:416
    ds_read_b128 v[104:107], v14 offset:896
    ds_read_b128 v[108:111], v14 offset:912
    v_mfma_f32_32x32x16_bf16 v[16:31], v[80:83], v[128:131], v[16:31]
    v_lshlrev_b32 v136, 16, v244
    v_and_b32 v137, 0xffff0000, v244
    v_mul_f32 v136, v136, v112
    v_mul_f32 v137, v137, v113
    v_cvt_pk_bf16_f32 v132, v136, v137
    v_lshlrev_b32 v138, 16, v245
    v_and_b32 v139, 0xffff0000, v245
    v_mfma_f32_32x32x16_bf16 v[32:47], v[84:87], v[128:131], v[32:47]
    v_mul_f32 v138, v138, v114
    v_mul_f32 v139, v139, v115
    v_cvt_pk_bf16_f32 v133, v138, v139
    v_lshlrev_b32 v140, 16, v246
    v_and_b32 v141, 0xffff0000, v246
    v_mul_f32 v140, v140, v116
    v_mul_f32 v141, v141, v117
    v_mfma_f32_32x32x16_bf16 v[48:63], v[128:131], v[88:91], v[48:63]
    v_cvt_pk_bf16_f32 v134, v140, v141
    v_lshlrev_b32 v142, 16, v247
    v_and_b32 v143, 0xffff0000, v247
    v_mul_f32 v142, v142, v118
    v_mul_f32 v143, v143, v119
    v_cvt_pk_bf16_f32 v135, v142, v143
    v_mfma_f32_16x16x32_bf16 v[64:67], v[80:83], v[120:123], v[64:67]
    s_waitcnt lgkmcnt(0)
    ds_read_b64_tr_b16 v[80:81], v13 offset:30720
    ds_read_b64_tr_b16 v[82:83], v13 offset:30976
    ds_read_b64_tr_b16 v[84:85], v13 offset:31744
    ds_read_b64_tr_b16 v[86:87], v13 offset:32000
    ds_read_b64_tr_b16 v[88:89], v13 offset:32768
    ds_read_b64_tr_b16 v[90:91], v13 offset:33024
    ds_read_b128 v[120:123], v15 offset:448
    ds_read_b128 v[112:115], v14 offset:960
    ds_read_b128 v[116:119], v14 offset:976
    v_mfma_f32_32x32x16_bf16 v[16:31], v[92:95], v[132:135], v[16:31]
    v_lshlrev_b32 v136, 16, v248
    v_and_b32 v137, 0xffff0000, v248
    v_mul_f32 v136, v136, v104
    v_mul_f32 v137, v137, v105
    v_cvt_pk_bf16_f32 v128, v136, v137
    v_lshlrev_b32 v138, 16, v249
    v_and_b32 v139, 0xffff0000, v249
    v_mfma_f32_32x32x16_bf16 v[32:47], v[96:99], v[132:135], v[32:47]
    v_mul_f32 v138, v138, v106
    v_mul_f32 v139, v139, v107
    v_cvt_pk_bf16_f32 v129, v138, v139
    v_lshlrev_b32 v140, 16, v250
    v_and_b32 v141, 0xffff0000, v250
    v_mul_f32 v140, v140, v108
    v_mul_f32 v141, v141, v109
    v_mfma_f32_32x32x16_bf16 v[48:63], v[132:135], v[100:103], v[48:63]
    v_cvt_pk_bf16_f32 v130, v140, v141
    v_lshlrev_b32 v142, 16, v251
    v_and_b32 v143, 0xffff0000, v251
    v_mul_f32 v142, v142, v110
    v_mul_f32 v143, v143, v111
    v_cvt_pk_bf16_f32 v131, v142, v143
    v_mfma_f32_16x16x32_bf16 v[64:67], v[92:95], v[124:127], v[64:67]
    s_waitcnt lgkmcnt(0)
    ds_read_b64_tr_b16 v[92:93], v13 offset:33792
    ds_read_b64_tr_b16 v[94:95], v13 offset:34048
    ds_read_b64_tr_b16 v[96:97], v13 offset:34816
    ds_read_b64_tr_b16 v[98:99], v13 offset:35072
    ds_read_b64_tr_b16 v[100:101], v13 offset:35840
    ds_read_b64_tr_b16 v[102:103], v13 offset:36096
    ds_read_b128 v[124:127], v15 offset:480
    v_mfma_f32_32x32x16_bf16 v[16:31], v[80:83], v[128:131], v[16:31]
    v_lshlrev_b32 v136, 16, v252
    v_and_b32 v137, 0xffff0000, v252
    v_mul_f32 v136, v136, v112
    v_mul_f32 v137, v137, v113
    v_cvt_pk_bf16_f32 v132, v136, v137
    v_lshlrev_b32 v138, 16, v253
    v_and_b32 v139, 0xffff0000, v253
    v_mfma_f32_32x32x16_bf16 v[32:47], v[84:87], v[128:131], v[32:47]
    v_mul_f32 v138, v138, v114
    v_mul_f32 v139, v139, v115
    v_cvt_pk_bf16_f32 v133, v138, v139
    v_lshlrev_b32 v140, 16, v254
    v_and_b32 v141, 0xffff0000, v254
    v_mul_f32 v140, v140, v116
    v_mul_f32 v141, v141, v117
    v_mfma_f32_32x32x16_bf16 v[48:63], v[128:131], v[88:91], v[48:63]
    v_cvt_pk_bf16_f32 v134, v140, v141
    v_lshlrev_b32 v142, 16, v255
    v_and_b32 v143, 0xffff0000, v255
    v_mul_f32 v142, v142, v118
    v_mul_f32 v143, v143, v119
    v_cvt_pk_bf16_f32 v135, v142, v143
    v_mfma_f32_16x16x32_bf16 v[64:67], v[80:83], v[120:123], v[64:67]
    s_waitcnt lgkmcnt(0)
    v_mfma_f32_32x32x16_bf16 v[16:31], v[92:95], v[132:135], v[16:31]
    v_mfma_f32_32x32x16_bf16 v[32:47], v[96:99], v[132:135], v[32:47]
    v_mfma_f32_32x32x16_bf16 v[48:63], v[132:135], v[100:103], v[48:63]
    v_mfma_f32_16x16x32_bf16 v[64:67], v[92:95], v[124:127], v[64:67]
    s_branch L_lpend
L_lpv1:
    s_cmp_eq_u32 s30, 1
    s_cbranch_scc0 L_lpv2
    ds_read_b128 v[104:107], v14 offset:0
    ds_read_b128 v[108:111], v14 offset:16
    ds_read_b64_tr_b16 v[80:81], v12 offset:0
    ds_read_b64_tr_b16 v[82:83], v12 offset:256
    ds_read_b64_tr_b16 v[84:85], v12 offset:1024
    ds_read_b64_tr_b16 v[86:87], v12 offset:1280
    ds_read_b64_tr_b16 v[88:89], v12 offset:2048
    ds_read_b64_tr_b16 v[90:91], v12 offset:2304
    ds_read_b128 v[112:115], v14 offset:64
    ds_read_b128 v[116:119], v14 offset:80
    ds_read_b128 v[120:123], v15 offset:0
    s_waitcnt lgkmcnt(9)
    v_lshlrev_b32 v136, 16, v192
    v_and_b32 v137, 0xffff0000, v192
    v_mul_f32 v136, v136, v104
    v_mul_f32 v137, v137, v105
    v_cvt_pk_bf16_f32 v128, v136, v137
    v_lshlrev_b32 v138, 16, v193
    v_and_b32 v139, 0xffff0000, v193
    v_mul_f32 v138, v138, v106
    v_mul_f32 v139, v139, v107
    v_cvt_pk_bf16_f32 v129, v138, v139
    v_lshlrev_b32 v140, 16, v194
    v_and_b32 v141, 0xffff0000, v194
    v_mul_f32 v140, v140, v108
    v_mul_f32 v141, v141, v109
    v_cvt_pk_bf16_f32 v130, v140, v141
    v_lshlrev_b32 v142, 16, v195
    v_and_b32 v143, 0xffff0000, v195
    v_mul_f32 v142, v142, v110
    v_mul_f32 v143, v143, v111
    v_cvt_pk_bf16_f32 v131, v142, v143
    s_waitcnt lgkmcnt(0)
    ds_read_b64_tr_b16 v[92:93], v12 offset:3072
    ds_read_b64_tr_b16 v[94:95], v12 offset:3328
    ds_read_b64_tr_b16 v[96:97], v12 offset:4096
    ds_read_b64_tr_b16 v[98:99], v12 offset:4352
    ds_read_b64_tr_b16 v[100:101], v12 offset:5120
    ds_read_b64_tr_b16 v[102:103], v12 offset:5376
    ds_read_b128 v[124:127], v15 offset:32
    ds_read_b128 v[104:107], v14 offset:128
    ds_read_b128 v[108:111], v14 offset:144
    s_nop 1
    v_mfma_f32_32x32x16_bf16 v[16:31], v[80:83], v[128:131], v[16:31]
    v_lshlrev_b32 v136, 16, v196
    v_and_b32 v137, 0xffff0000, v196
    v_mul_f32 v136, v136, v112
    v_mul_f32 v137, v137, v113
    v_cvt_pk_bf16_f32 v132, v136, v137
    v_lshlrev_b32 v138, 16, v197
    v_and_b32 v139, 0xffff0000, v197
    v_mfma_f32_32x32x16_bf16 v[32:47], v[84:87], v[128:131], v[32:47]
    global_load_lds_dwordx4 v150, s[38:39] offset:0
    v_mul_f32 v138, v138, v114
    v_mul_f32 v139, v139, v115
    v_cvt_pk_bf16_f32 v133, v138, v139
    v_lshlrev_b32 v140, 16, v198
    v_and_b32 v141, 0xffff0000, v198
    v_mul_f32 v140, v140, v116
    v_mul_f32 v141, v141, v117
    v_mfma_f32_32x32x16_bf16 v[48:63], v[128:131], v[88:91], v[48:63]
    v_cvt_pk_bf16_f32 v134, v140, v141
    v_lshlrev_b32 v142, 16, v199
    v_and_b32 v143, 0xffff0000, v199
    v_mul_f32 v142, v142, v118
    v_mul_f32 v143, v143, v119
    v_cvt_pk_bf16_f32 v135, v142, v143
    v_mfma_f32_16x16x32_bf16 v[64:67], v[84:87], v[120:123], v[64:67]
    s_waitcnt lgkmcnt(0)
    ds_read_b64_tr_b16 v[80:81], v12 offset:6144
    ds_read_b64_tr_b16 v[82:83], v12 offset:6400
    ds_read_b64_tr_b16 v[84:85], v12 offset:7168
    ds_read_b64_tr_b16 v[86:87], v12 offset:7424
    ds_read_b64_tr_b16 v[88:89], v12 offset:8192
    ds_read_b64_tr_b16 v[90:91], v12 offset:8448
    ds_read_b128 v[120:123], v15 offset:64
    ds_read_b128 v[112:115], v14 offset:192
    ds_read_b128 v[116:119], v14 offset:208
    v_mfma_f32_32x32x16_bf16 v[16:31], v[92:95], v[132:135], v[16:31]
    v_lshlrev_b32 v136, 16, v200
    v_and_b32 v137, 0xffff0000, v200
    v_mul_f32 v136, v136, v104
    v_mul_f32 v137, v137, v105
    v_cvt_pk_bf16_f32 v128, v136, v137
    v_lshlrev_b32 v138, 16, v201
    v_and_b32 v139, 0xffff0000, v201
    v_mfma_f32_32x32x16_bf16 v[32:47], v[96:99], v[132:135], v[32:47]
    global_load_lds_dwordx4 v150, s[38:39] offset:1024
    v_mul_f32 v138, v138, v106
    v_mul_f32 v139, v139, v107
    v_cvt_pk_bf16_f32 v129, v138, v139
    v_lshlrev_b32 v140, 16, v202
    v_and_b32 v141, 0xffff0000, v202
    v_mul_f32 v140, v140, v108
    v_mul_f32 v141, v141, v109
    v_mfma_f32_32x32x16_bf16 v[48:63], v[132:135], v[100:103], v[48:63]
    v_cvt_pk_bf16_f32 v130, v140, v141
    v_lshlrev_b32 v142, 16, v203
    v_and_b32 v143, 0xffff0000, v203
    v_mul_f32 v142, v142, v110
    v_mul_f32 v143, v143, v111
    v_cvt_pk_bf16_f32 v131, v142, v143
    v_mfma_f32_16x16x32_bf16 v[64:67], v[96:99], v[124:127], v[64:67]
    s_waitcnt lgkmcnt(0)
    ds_read_b64_tr_b16 v[92:93], v12 offset:9216
    ds_read_b64_tr_b16 v[94:95], v12 offset:9472
    ds_read_b64_tr_b16 v[96:97], v12 offset:10240
    ds_read_b64_tr_b16 v[98:99], v12 offset:10496
    ds_read_b64_tr_b16 v[100:101], v12 offset:11264
    ds_read_b64_tr_b16 v[102:103], v12 offset:11520
    ds_read_b128 v[124:127], v15 offset:96
    ds_read_b128 v[104:107], v14 offset:256
    ds_read_b128 v[108:111], v14 offset:272
    v_mfma_f32_32x32x16_bf16 v[16:31], v[80:83], v[128:131], v[16:31]
    v_lshlrev_b32 v136, 16, v204
    v_and_b32 v137, 0xffff0000, v204
    v_mul_f32 v136, v136, v112
    v_mul_f32 v137, v137, v113
    v_cvt_pk_bf16_f32 v132, v136, v137
    v_lshlrev_b32 v138, 16, v205
    v_and_b32 v139, 0xffff0000, v205
    v_mfma_f32_32x32x16_bf16 v[32:47], v[84:87], v[128:131], v[32:47]
    global_load_lds_dwordx4 v150, s[38:39] offset:2048
    v_mul_f32 v138, v138, v114
    v_mul_f32 v139, v139, v115
    v_cvt_pk_bf16_f32 v133, v138, v139
    v_lshlrev_b32 v140, 16, v206
    v_and_b32 v141, 0xffff0000, v206
    v_mul_f32 v140, v140, v116
    v_mul_f32 v141, v141, v117
    v_mfma_f32_32x32x16_bf16 v[48:63], v[128:131], v[88:91], v[48:63]
    v_cvt_pk_bf16_f32 v134, v140, v141
    v_lshlrev_b32 v142, 16, v207
    v_and_b32 v143, 0xffff0000, v207
    v_mul_f32 v142, v142, v118
    v_mul_f32 v143, v143, v119
    v_cvt_pk_bf16_f32 v135, v142, v143
    v_mfma_f32_16x16x32_bf16 v[64:67], v[84:87], v[120:123], v[64:67]
    s_waitcnt lgkmcnt(0)
    s_waitcnt vmcnt(3)
    s_barrier
    ds_read_b64_tr_b16 v[80:81], v13 offset:0
    ds_read_b64_tr_b16 v[82:83], v13 offset:256
    ds_read_b64_tr_b16 v[84:85], v13 offset:1024
    ds_read_b64_tr_b16 v[86:87], v13 offset:1280
    ds_read_b64_tr_b16 v[88:89], v13 offset:2048
    ds_read_b64_tr_b16 v[90:91], v13 offset:2304
    ds_read_b128 v[120:123], v15 offset:128
    ds_read_b128 v[112:115], v14 offset:320
    ds_read_b128 v[116:119], v14 offset:336
    v_mfma_f32_32x32x16_bf16 v[16:31], v[92:95], v[132:135], v[16:31]
    v_lshlrev_b32 v136, 16, v208
    v_and_b32 v137, 0xffff0000, v208
    v_mul_f32 v136, v136, v104
    v_mul_f32 v137, v137, v105
    v_cvt_pk_bf16_f32 v128, v136, v137
    v_lshlrev_b32 v138, 16, v209
    v_and_b32 v139, 0xffff0000, v209
    v_mfma_f32_32x32x16_bf16 v[32:47], v[96:99], v[132:135], v[32:47]
    s_add_u32 s38, s38, 196608
    s_addc_u32 s39, s39, 0
    s_add_u32 m0, m0, 12288
    s_nop 0
    global_load_lds_dwordx4 v150, s[38:39] offset:0
    v_mul_f32 v138, v138, v106
    v_mul_f32 v139, v139, v107
    v_cvt_pk_bf16_f32 v129, v138, v139
    v_lshlrev_b32 v140, 16, v210
    v_and_b32 v141, 0xffff0000, v210
    v_mul_f32 v140, v140, v108
    v_mul_f32 v141, v141, v109
    v_mfma_f32_32x32x16_bf16 v[48:63], v[132:135], v[100:103], v[48:63]
    v_cvt_pk_bf16_f32 v130, v140, v141
    v_lshlrev_b32 v142, 16, v211
    v_and_b32 v143, 0xffff0000, v211
    v_mul_f32 v142, v142, v110
    v_mul_f32 v143, v143, v111
    v_cvt_pk_bf16_f32 v131, v142, v143
    v_mfma_f32_16x16x32_bf16 v[64:67], v[96:99], v[124:127], v[64:67]
    s_waitcnt lgkmcnt(0)
    ds_read_b64_tr_b16 v[92:93], v13 offset:3072
    ds_read_b64_tr_b16 v[94:95], v13 offset:3328
    ds_read_b64_tr_b16 v[96:97], v13 offset:4096
    ds_read_b64_tr_b16 v[98:99], v13 offset:4352
    ds_read_b64_tr_b16 v[100:101], v13 offset:5120
    ds_read_b64_tr_b16 v[102:103], v13 offset:5376
    ds_read_b128 v[124:127], v15 offset:160
    ds_read_b128 v[104:107], v14 offset:384
    ds_read_b128 v[108:111], v14 offset:400
    v_mfma_f32_32x32x16_bf16 v[16:31], v[80:83], v[128:131], v[16:31]
    v_lshlrev_b32 v136, 16, v212
    v_and_b32 v137, 0xffff0000, v212
    v_mul_f32 v136, v136, v112
    v_mul_f32 v137, v137, v113
    v_cvt_pk_bf16_f32 v132, v136, v137
    v_lshlrev_b32 v138, 16, v213
    v_and_b32 v139, 0xffff0000, v213
    v_mfma_f32_32x32x16_bf16 v[32:47], v[84:87], v[128:131], v[32:47]
    global_load_lds_dwordx4 v150, s[38:39] offset:1024
    v_mul_f32 v138, v138, v114
    v_mul_f32 v139, v139, v115
    v_cvt_pk_bf16_f32 v133, v138, v139
    v_lshlrev_b32 v140, 16, v214
    v_and_b32 v141, 0xffff0000, v214
    v_mul_f32 v140, v140, v116
    v_mul_f32 v141, v141, v117
    v_mfma_f32_32x32x16_bf16 v[48:63], v[128:131], v[88:91], v[48:63]
    v_cvt_pk_bf16_f32 v134, v140, v141
    v_lshlrev_b32 v142, 16, v215
    v_and_b32 v143, 0xffff0000, v215
    v_mul_f32 v142, v142, v118
    v_mul_f32 v143, v143, v119
    v_cvt_pk_bf16_f32 v135, v142, v143
    v_mfma_f32_16x16x32_bf16 v[64:67], v[84:87], v[120:123], v[64:67]
    s_waitcnt lgkmcnt(0)
    ds_read_b64_tr_b16 v[80:81], v13 offset:6144
    ds_read_b64_tr_b16 v[82:83], v13 offset:6400
    ds_read_b64_tr_b16 v[84:85], v13 offset:7168
    ds_read_b64_tr_b16 v[86:87], v13 offset:7424
    ds_read_b64_tr_b16 v[88:89], v13 offset:8192
    ds_read_b64_tr_b16 v[90:91], v13 offset:8448
    ds_read_b128 v[120:123], v15 offset:192
    ds_read_b128 v[112:115], v14 offset:448
    ds_read_b128 v[116:119], v14 offset:464
    v_mfma_f32_32x32x16_bf16 v[16:31], v[92:95], v[132:135], v[16:31]
    v_lshlrev_b32 v136, 16, v216
    v_and_b32 v137, 0xffff0000, v216
    v_mul_f32 v136, v136, v104
    v_mul_f32 v137, v137, v105
    v_cvt_pk_bf16_f32 v128, v136, v137
    v_lshlrev_b32 v138, 16, v217
    v_and_b32 v139, 0xffff0000, v217
    v_mfma_f32_32x32x16_bf16 v[32:47], v[96:99], v[132:135], v[32:47]
    global_load_lds_dwordx4 v150, s[38:39] offset:2048
    v_mul_f32 v138, v138, v106
    v_mul_f32 v139, v139, v107
    v_cvt_pk_bf16_f32 v129, v138, v139
    v_lshlrev_b32 v140, 16, v218
    v_and_b32 v141, 0xffff0000, v218
    v_mul_f32 v140, v140, v108
    v_mul_f32 v141, v141, v109
    v_mfma_f32_32x32x16_bf16 v[48:63], v[132:135], v[100:103], v[48:63]
    v_cvt_pk_bf16_f32 v130, v140, v141
    v_lshlrev_b32 v142, 16, v219
    v_and_b32 v143, 0xffff0000, v219
    v_mul_f32 v142, v142, v110
    v_mul_f32 v143, v143, v111
    v_cvt_pk_bf16_f32 v131, v142, v143
    v_mfma_f32_16x16x32_bf16 v[64:67], v[96:99], v[124:127], v[64:67]
    s_waitcnt lgkmcnt(0)
    ds_read_b64_tr_b16 v[92:93], v13 offset:9216
    ds_read_b64_tr_b16 v[94:95], v13 offset:9472
    ds_read_b64_tr_b16 v[96:97], v13 offset:10240
    ds_read_b64_tr_b16 v[98:99], v13 offset:10496
    ds_read_b64_tr_b16 v[100:101], v13 offset:11264
    ds_read_b64_tr_b16 v[102:103], v13 offset:11520
    ds_read_b128 v[124:127], v15 offset:224
    ds_read_b128 v[104:107], v14 offset:512
    ds_read_b128 v[108:111], v14 offset:528
    v_mfma_f32_32x32x16_bf16 v[16:31], v[80:83], v[128:131], v[16:31]
    v_lshlrev_b32 v136, 16, v220
    v_and_b32 v137, 0xffff0000, v220
    v_mul_f32 v136, v136, v112
    v_mul_f32 v137, v137, v113
    v_cvt_pk_bf16_f32 v132, v136, v137
    v_lshlrev_b32 v138, 16, v221
    v_and_b32 v139, 0xffff0000, v221
    v_mfma_f32_32x32x16_bf16 v[32:47], v[84:87], v[128:131], v[32:47]
    v_mul_f32 v138, v138, v114
    v_mul_f32 v139, v139, v115
    v_cvt_pk_bf16_f32 v133, v138, v139
    v_lshlrev_b32 v140, 16, v222
    v_and_b32 v141, 0xffff0000, v222
    v_mul_f32 v140, v140, v116
    v_mul_f32 v141, v141, v117
    v_mfma_f32_32x32x16_bf16 v[48:63], v[128:131], v[88:91], v[48:63]
    v_cvt_pk_bf16_f32 v134, v140, v141
    v_lshlrev_b32 v142, 16, v223
    v_and_b32 v143, 0xffff0000, v223
    v_mul_f32 v142, v142, v118
    v_mul_f32 v143, v143, v119
    v_cvt_pk_bf16_f32 v135, v142, v143
    v_mfma_f32_16x16x32_bf16 v[64:67], v[84:87], v[120:123], v[64:67]
    s_waitcnt lgkmcnt(0)
    s_waitcnt vmcnt(3)
    s_barrier
    ds_read_b64_tr_b16 v[80:81], v13 offset:12288
    ds_read_b64_tr_b16 v[82:83], v13 offset:12544
    ds_read_b64_tr_b16 v[84:85], v13 offset:13312
    ds_read_b64_tr_b16 v[86:87], v13 offset:13568
    ds_read_b64_tr_b16 v[88:89], v13 offset:14336
    ds_read_b64_tr_b16 v[90:91], v13 offset:14592
    ds_read_b128 v[120:123], v15 offset:256
    ds_read_b128 v[112:115], v14 offset:576
    ds_read_b128 v[116:119], v14 offset:592
    v_mfma_f32_32x32x16_bf16 v[16:31], v[92:95], v[132:135], v[16:31]
    v_lshlrev_b32 v136, 16, v224
    v_and_b32 v137, 0xffff0000, v224
    v_mul_f32 v136, v136, v104
    v_mul_f32 v137, v137, v105
    v_cvt_pk_bf16_f32 v128, v136, v137
    v_lshlrev_b32 v138, 16, v225
    v_and_b32 v139, 0xffff0000, v225
    v_mfma_f32_32x32x16_bf16 v[32:47], v[96:99], v[132:135], v[32:47]
    v_mul_f32 v138, v138, v106
    v_mul_f32 v139, v139, v107
    v_cvt_pk_bf16_f32 v129, v138, v139
    v_lshlrev_b32 v140, 16, v226
    v_and_b32 v141, 0xffff0000, v226
    v_mul_f32 v140, v140, v108
    v_mul_f32 v141, v141, v109
    v_mfma_f32_32x32x16_bf16 v[48:63], v[132:135], v[100:103], v[48:63]
    v_cvt_pk_bf16_f32 v130, v140, v141
    v_lshlrev_b32 v142, 16, v227
    v_and_b32 v143, 0xffff0000, v227
    v_mul_f32 v142, v142, v110
    v_mul_f32 v143, v143, v111
    v_cvt_pk_bf16_f32 v131, v142, v143
    v_mfma_f32_16x16x32_bf16 v[64:67], v[96:99], v[124:127], v[64:67]
    s_waitcnt lgkmcnt(0)
    ds_read_b64_tr_b16 v[92:93], v13 offset:15360
    ds_read_b64_tr_b16 v[94:95], v13 offset:15616
    ds_read_b64_tr_b16 v[96:97], v13 offset:16384
    ds_read_b64_tr_b16 v[98:99], v13 offset:16640
    ds_read_b64_tr_b16 v[100:101], v13 offset:17408
    ds_read_b64_tr_b16 v[102:103], v13 offset:17664
    ds_read_b128 v[124:127], v15 offset:288
    ds_read_b128 v[104:107], v14 offset:640
    ds_read_b128 v[108:111], v14 offset:656
    v_mfma_f32_32x32x16_bf16 v[16:31], v[80:83], v[128:131], v[16:31]
    v_lshlrev_b32 v136, 16, v228
    v_and_b32 v137, 0xffff0000, v228
    v_mul_f32 v136, v136, v112
    v_mul_f32 v137, v137, v113
    v_cvt_pk_bf16_f32 v132, v136, v137
    v_lshlrev_b32 v138, 16, v229
    v_and_b32 v139, 0xffff0000, v229
    v_mfma_f32_32x32x16_bf16 v[32:47], v[84:87], v[128:131], v[32:47]
    v_mul_f32 v138, v138, v114
    v_mul_f32 v139, v139, v115
    v_cvt_pk_bf16_f32 v133, v138, v139
    v_lshlrev_b32 v140, 16, v230
    v_and_b32 v141, 0xffff0000, v230
    v_mul_f32 v140, v140, v116
    v_mul_f32 v141, v141, v117
    v_mfma_f32_32x32x16_bf16 v[48:63], v[128:131], v[88:91], v[48:63]
    v_cvt_pk_bf16_f32 v134, v140, v141
    v_lshlrev_b32 v142, 16, v231
    v_and_b32 v143, 0xffff0000, v231
    v_mul_f32 v142, v142, v118
    v_mul_f32 v143, v143, v119
    v_cvt_pk_bf16_f32 v135, v142, v143
    v_mfma_f32_16x16x32_bf16 v[64:67], v[84:87], v[120:123], v[64:67]
    s_waitcnt lgkmcnt(0)
    ds_read_b64_tr_b16 v[80:81], v13 offset:18432
    ds_read_b64_tr_b16 v[82:83], v13 offset:18688
    ds_read_b64_tr_b16 v[84:85], v13 offset:19456
    ds_read_b64_tr_b16 v[86:87], v13 offset:19712
    ds_read_b64_tr_b16 v[88:89], v13 offset:20480
    ds_read_b64_tr_b16 v[90:91], v13 offset:20736
    ds_read_b128 v[120:123], v15 offset:320
    ds_read_b128 v[112:115], v14 offset:704
    ds_read_b128 v[116:119], v14 offset:720
    v_mfma_f32_32x32x16_bf16 v[16:31], v[92:95], v[132:135], v[16:31]
    v_lshlrev_b32 v136, 16, v232
    v_and_b32 v137, 0xffff0000, v232
    v_mul_f32 v136, v136, v104
    v_mul_f32 v137, v137, v105
    v_cvt_pk_bf16_f32 v128, v136, v137
    v_lshlrev_b32 v138, 16, v233
    v_and_b32 v139, 0xffff0000, v233
    v_mfma_f32_32x32x16_bf16 v[32:47], v[96:99], v[132:135], v[32:47]
    v_mul_f32 v138, v138, v106
    v_mul_f32 v139, v139, v107
    v_cvt_pk_bf16_f32 v129, v138, v139
    v_lshlrev_b32 v140, 16, v234
    v_and_b32 v141, 0xffff0000, v234
    v_mul_f32 v140, v140, v108
    v_mul_f32 v141, v141, v109
    v_mfma_f32_32x32x16_bf16 v[48:63], v[132:135], v[100:103], v[48:63]
    v_cvt_pk_bf16_f32 v130, v140, v141
    v_lshlrev_b32 v142, 16, v235
    v_and_b32 v143, 0xffff0000, v235
    v_mul_f32 v142, v142, v110
    v_mul_f32 v143, v143, v111
    v_cvt_pk_bf16_f32 v131, v142, v143
    v_mfma_f32_16x16x32_bf16 v[64:67], v[96:99], v[124:127], v[64:67]
    s_waitcnt lgkmcnt(0)
    ds_read_b64_tr_b16 v[92:93], v13 offset:21504
    ds_read_b64_tr_b16 v[94:95], v13 offset:21760
    ds_read_b64_tr_b16 v[96:97], v13 offset:22528
    ds_read_b64_tr_b16 v[98:99], v13 offset:22784
    ds_read_b64_tr_b16 v[100:101], v13 offset:23552
    ds_read_b64_tr_b16 v[102:103], v13 offset:23808
    ds_read_b128 v[124:127], v15 offset:352
    ds_read_b128 v[104:107], v14 offset:768
    ds_read_b128 v[108:111], v14 offset:784
    v_mfma_f32_32x32x16_bf16 v[16:31], v[80:83], v[128:131], v[16:31]
    v_lshlrev_b32 v136, 16, v236
    v_and_b32 v137, 0xffff0000, v236
    v_mul_f32 v136, v136, v112
    v_mul_f32 v137, v137, v113
    v_cvt_pk_bf16_f32 v132, v136, v137
    v_lshlrev_b32 v138, 16, v237
    v_and_b32 v139, 0xffff0000, v237
    v_mfma_f32_32x32x16_bf16 v[32:47], v[84:87], v[128:131], v[32:47]
    v_mul_f32 v138, v138, v114
    v_mul_f32 v139, v139, v115
    v_cvt_pk_bf16_f32 v133, v138, v139
    v_lshlrev_b32 v140, 16, v238
    v_and_b32 v141, 0xffff0000, v238
    v_mul_f32 v140, v140, v116
    v_mul_f32 v141, v141, v117
    v_mfma_f32_32x32x16_bf16 v[48:63], v[128:131], v[88:91], v[48:63]
    v_cvt_pk_bf16_f32 v134, v140, v141
    v_lshlrev_b32 v142, 16, v239
    v_and_b32 v143, 0xffff0000, v239
    v_mul_f32 v142, v142, v118
    v_mul_f32 v143, v143, v119
    v_cvt_pk_bf16_f32 v135, v142, v143
    v_mfma_f32_16x16x32_bf16 v[64:67], v[84:87], v[120:123], v[64:67]
    s_waitcnt lgkmcnt(0)
    s_waitcnt vmcnt(0)
    s_barrier
    global_load_dwordx4 v[4:7], v11, s[24:25] sc1
    ds_read_b64_tr_b16 v[80:81], v13 offset:24576
    ds_read_b64_tr_b16 v[82:83], v13 offset:24832
    ds_read_b64_tr_b16 v[84:85], v13 offset:25600
    ds_read_b64_tr_b16 v[86:87], v13 offset:25856
    ds_read_b64_tr_b16 v[88:89], v13 offset:26624
    ds_read_b64_tr_b16 v[90:91], v13 offset:26880
    ds_read_b128 v[120:123], v15 offset:384
    ds_read_b128 v[112:115], v14 offset:832
    ds_read_b128 v[116:119], v14 offset:848
    v_mfma_f32_32x32x16_bf16 v[16:31], v[92:95], v[132:135], v[16:31]
    v_lshlrev_b32 v136, 16, v240
    v_and_b32 v137, 0xffff0000, v240
    v_mul_f32 v136, v136, v104
    v_mul_f32 v137, v137, v105
    v_cvt_pk_bf16_f32 v128, v136, v137
    v_lshlrev_b32 v138, 16, v241
    v_and_b32 v139, 0xffff0000, v241
    v_mfma_f32_32x32x16_bf16 v[32:47], v[96:99], v[132:135], v[32:47]
    v_mul_f32 v138, v138, v106
    v_mul_f32 v139, v139, v107
    v_cvt_pk_bf16_f32 v129, v138, v139
    v_lshlrev_b32 v140, 16, v242
    v_and_b32 v141, 0xffff0000, v242
    v_mul_f32 v140, v140, v108
    v_mul_f32 v141, v141, v109
    v_mfma_f32_32x32x16_bf16 v[48:63], v[132:135], v[100:103], v[48:63]
    v_cvt_pk_bf16_f32 v130, v140, v141
    v_lshlrev_b32 v142, 16, v243
    v_and_b32 v143, 0xffff0000, v243
    v_mul_f32 v142, v142, v110
    v_mul_f32 v143, v143, v111
    v_cvt_pk_bf16_f32 v131, v142, v143
    v_mfma_f32_16x16x32_bf16 v[64:67], v[96:99], v[124:127], v[64:67]
    s_waitcnt lgkmcnt(0)
    ds_read_b64_tr_b16 v[92:93], v13 offset:27648
    ds_read_b64_tr_b16 v[94:95], v13 offset:27904
    ds_read_b64_tr_b16 v[96:97], v13 offset:28672
    ds_read_b64_tr_b16 v[98:99], v13 offset:28928
    ds_read_b64_tr_b16 v[100:101], v13 offset:29696
    ds_read_b64_tr_b16 v[102:103], v13 offset:29952
    ds_read_b128 v[124:127], v15 offset:416
    ds_read_b128 v[104:107], v14 offset:896
    ds_read_b128 v[108:111], v14 offset:912
    v_mfma_f32_32x32x16_bf16 v[16:31], v[80:83], v[128:131], v[16:31]
    v_lshlrev_b32 v136, 16, v244
    v_and_b32 v137, 0xffff0000, v244
    v_mul_f32 v136, v136, v112
    v_mul_f32 v137, v137, v113
    v_cvt_pk_bf16_f32 v132, v136, v137
    v_lshlrev_b32 v138, 16, v245
    v_and_b32 v139, 0xffff0000, v245
    v_mfma_f32_32x32x16_bf16 v[32:47], v[84:87], v[128:131], v[32:47]
    v_mul_f32 v138, v138, v114
    v_mul_f32 v139, v139, v115
    v_cvt_pk_bf16_f32 v133, v138, v139
    v_lshlrev_b32 v140, 16, v246
    v_and_b32 v141, 0xffff0000, v246
    v_mul_f32 v140, v140, v116
    v_mul_f32 v141, v141, v117
    v_mfma_f32_32x32x16_bf16 v[48:63], v[128:131], v[88:91], v[48:63]
    v_cvt_pk_bf16_f32 v134, v140, v141
    v_lshlrev_b32 v142, 16, v247
    v_and_b32 v143, 0xffff0000, v247
    v_mul_f32 v142, v142, v118
    v_mul_f32 v143, v143, v119
    v_cvt_pk_bf16_f32 v135, v142, v143
    v_mfma_f32_16x16x32_bf16 v[64:67], v[84:87], v[120:123], v[64:67]
    s_waitcnt lgkmcnt(0)
    ds_read_b64_tr_b16 v[80:81], v13 offset:30720
    ds_read_b64_tr_b16 v[82:83], v13 offset:30976
    ds_read_b64_tr_b16 v[84:85], v13 offset:31744
    ds_read_b64_tr_b16 v[86:87], v13 offset:32000
    ds_read_b64_tr_b16 v[88:89], v13 offset:32768
    ds_read_b64_tr_b16 v[90:91], v13 offset:33024
    ds_read_b128 v[120:123], v15 offset:448
    ds_read_b128 v[112:115], v14 offset:960
    ds_read_b128 v[116:119], v14 offset:976
    v_mfma_f32_32x32x16_bf16 v[16:31], v[92:95], v[132:135], v[16:31]
    v_lshlrev_b32 v136, 16, v248
    v_and_b32 v137, 0xffff0000, v248
    v_mul_f32 v136, v136, v104
    v_mul_f32 v137, v137, v105
    v_cvt_pk_bf16_f32 v128, v136, v137
    v_lshlrev_b32 v138, 16, v249
    v_and_b32 v139, 0xffff0000, v249
    v_mfma_f32_32x32x16_bf16 v[32:47], v[96:99], v[132:135], v[32:47]
    v_mul_f32 v138, v138, v106
    v_mul_f32 v139, v139, v107
    v_cvt_pk_bf16_f32 v129, v138, v139
    v_lshlrev_b32 v140, 16, v250
    v_and_b32 v141, 0xffff0000, v250
    v_mul_f32 v140, v140, v108
    v_mul_f32 v141, v141, v109
    v_mfma_f32_32x32x16_bf16 v[48:63], v[132:135], v[100:103], v[48:63]
    v_cvt_pk_bf16_f32 v130, v140, v141
    v_lshlrev_b32 v142, 16, v251
    v_and_b32 v143, 0xffff0000, v251
    v_mul_f32 v142, v142, v110
    v_mul_f32 v143, v143, v111
    v_cvt_pk_bf16_f32 v131, v142, v143
    v_mfma_f32_16x16x32_bf16 v[64:67], v[96:99], v[124:127], v[64:67]
    s_waitcnt lgkmcnt(0)
    ds_read_b64_tr_b16 v[92:93], v13 offset:33792
    ds_read_b64_tr_b16 v[94:95], v13 offset:34048
    ds_read_b64_tr_b16 v[96:97], v13 offset:34816
    ds_read_b64_tr_b16 v[98:99], v13 offset:35072
    ds_read_b64_tr_b16 v[100:101], v13 offset:35840
    ds_read_b64_tr_b16 v[102:103], v13 offset:36096
    ds_read_b128 v[124:127], v15 offset:480
    v_mfma_f32_32x32x16_bf16 v[16:31], v[80:83], v[128:131], v[16:31]
    v_lshlrev_b32 v136, 16, v252
    v_and_b32 v137, 0xffff0000, v252
    v_mul_f32 v136, v136, v112
    v_mul_f32 v137, v137, v113
    v_cvt_pk_bf16_f32 v132, v136, v137
    v_lshlrev_b32 v138, 16, v253
    v_and_b32 v139, 0xffff0000, v253
    v_mfma_f32_32x32x16_bf16 v[32:47], v[84:87], v[128:131], v[32:47]
    v_mul_f32 v138, v138, v114
    v_mul_f32 v139, v139, v115
    v_cvt_pk_bf16_f32 v133, v138, v139
    v_lshlrev_b32 v140, 16, v254
    v_and_b32 v141, 0xffff0000, v254
    v_mul_f32 v140, v140, v116
    v_mul_f32 v141, v141, v117
    v_mfma_f32_32x32x16_bf16 v[48:63], v[128:131], v[88:91], v[48:63]
    v_cvt_pk_bf16_f32 v134, v140, v141
    v_lshlrev_b32 v142, 16, v255
    v_and_b32 v143, 0xffff0000, v255
    v_mul_f32 v142, v142, v118
    v_mul_f32 v143, v143, v119
    v_cvt_pk_bf16_f32 v135, v142, v143
    v_mfma_f32_16x16x32_bf16 v[64:67], v[84:87], v[120:123], v[64:67]
    s_waitcnt lgkmcnt(0)
    v_mfma_f32_32x32x16_bf16 v[16:31], v[92:95], v[132:135], v[16:31]
    v_mfma_f32_32x32x16_bf16 v[32:47], v[96:99], v[132:135], v[32:47]
    v_mfma_f32_32x32x16_bf16 v[48:63], v[132:135], v[100:103], v[48:63]
    v_mfma_f32_16x16x32_bf16 v[64:67], v[96:99], v[124:127], v[64:67]
    s_branch L_lpend
L_lpv2:
    s_cmp_eq_u32 s30, 2
    s_cbranch_scc0 L_lpv3
    ds_read_b128 v[104:107], v14 offset:0
    ds_read_b128 v[108:111], v14 offset:16
    ds_read_b64_tr_b16 v[80:81], v12 offset:0
    ds_read_b64_tr_b16 v[82:83], v12 offset:256
    ds_read_b64_tr_b16 v[84:85], v12 offset:1024
    ds_read_b64_tr_b16 v[86:87], v12 offset:1280
    ds_read_b64_tr_b16 v[88:89], v12 offset:2048
    ds_read_b64_tr_b16 v[90:91], v12 offset:2304
    ds_read_b128 v[112:115], v14 offset:64
    ds_read_b128 v[116:119], v14 offset:80
    ds_read_b128 v[120:123], v15 offset:0
    s_waitcnt lgkmcnt(9)
    v_lshlrev_b32 v136, 16, v192
    v_and_b32 v137, 0xffff0000, v192
    v_mul_f32 v136, v136, v104
    v_mul_f32 v137, v137, v105
    v_cvt_pk_bf16_f32 v128, v136, v137
    v_lshlrev_b32 v138, 16, v193
    v_and_b32 v139, 0xffff0000, v193
    v_mul_f32 v138, v138, v106
    v_mul_f32 v139, v139, v107
    v_cvt_pk_bf16_f32 v129, v138, v139
    v_lshlrev_b32 v140, 16, v194
    v_and_b32 v141, 0xffff0000, v194
    v_mul_f32 v140, v140, v108
    v_mul_f32 v141, v141, v109
    v_cvt_pk_bf16_f32 v130, v140, v141
    v_lshlrev_b32 v142, 16, v195
    v_and_b32 v143, 0xffff0000, v195
    v_mul_f32 v142, v142, v110
    v_mul_f32 v143, v143, v111
    v_cvt_pk_bf16_f32 v131, v142, v143
    s_waitcnt lgkmcnt(0)
    ds_read_b64_tr_b16 v[92:93], v12 offset:3072
    ds_read_b64_tr_b16 v[94:95], v12 offset:3328
    ds_read_b64_tr_b16 v[96:97], v12 offset:4096
    ds_read_b64_tr_b16 v[98:99], v12 offset:4352
    ds_read_b64_tr_b16 v[100:101], v12 offset:5120
    ds_read_b64_tr_b16 v[102:103], v12 offset:5376
    ds_read_b128 v[124:127], v15 offset:32
    ds_read_b128 v[104:107], v14 offset:128
    ds_read_b128 v[108:111], v14 offset:144
    s_nop 1
    v_mfma_f32_32x32x16_bf16 v[16:31], v[80:83], v[128:131], v[16:31]
    v_lshlrev_b32 v136, 16, v196
    v_and_b32 v137, 0xffff0000, v196
    v_mul_f32 v136, v136, v112
    v_mul_f32 v137, v137, v113
    v_cvt_pk_bf16_f32 v132, v136, v137
    v_lshlrev_b32 v138, 16, v197
    v_and_b32 v139, 0xffff0000, v197
    v_mfma_f32_32x32x16_bf16 v[32:47], v[84:87], v[128:131], v[32:47]
    global_load_lds_dwordx4 v150, s[38:39] offset:0
    v_mul_f32 v138, v138, v114
    v_mul_f32 v139, v139, v115
    v_cvt_pk_bf16_f32 v133, v138, v139
    v_lshlrev_b32 v140, 16, v198
    v_and_b32 v141, 0xffff0000, v198
    v_mul_f32 v140, v140, v116
    v_mul_f32 v141, v141, v117
    v_mfma_f32_32x32x16_bf16 v[48:63], v[128:131], v[88:91], v[48:63]
    v_cvt_pk_bf16_f32 v134, v140, v141
    v_lshlrev_b32 v142, 16, v199
    v_and_b32 v143, 0xffff0000, v199
    v_mul_f32 v142, v142, v118
    v_mul_f32 v143, v143, v119
    v_cvt_pk_bf16_f32 v135, v142, v143
    v_mfma_f32_16x16x32_bf16 v[64:67], v[88:91], v[120:123], v[64:67]
    s_waitcnt lgkmcnt(0)
    ds_read_b64_tr_b16 v[80:81], v12 offset:6144
    ds_read_b64_tr_b16 v[82:83], v12 offset:6400
    ds_read_b64_tr_b16 v[84:85], v12 offset:7168
    ds_read_b64_tr_b16 v[86:87], v12 offset:7424
    ds_read_b64_tr_b16 v[88:89], v12 offset:8192
    ds_read_b64_tr_b16 v[90:91], v12 offset:8448
    ds_read_b128 v[120:123], v15 offset:64
    ds_read_b128 v[112:115], v14 offset:192
    ds_read_b128 v[116:119], v14 offset:208
    v_mfma_f32_32x32x16_bf16 v[16:31], v[92:95], v[132:135], v[16:31]
    v_lshlrev_b32 v136, 16, v200
    v_and_b32 v137, 0xffff0000, v200
    v_mul_f32 v136, v136, v104
    v_mul_f32 v137, v137, v105
    v_cvt_pk_bf16_f32 v128, v136, v137
    v_lshlrev_b32 v138, 16, v201
    v_and_b32 v139, 0xffff0000, v201
    v_mfma_f32_32x32x16_bf16 v[32:47], v[96:99], v[132:135], v[32:47]
    global_load_lds_dwordx4 v150, s[38:39] offset:1024
    v_mul_f32 v138, v138, v106
    v_mul_f32 v139, v139, v107
    v_cvt_pk_bf16_f32 v129, v138, v139
    v_lshlrev_b32 v140, 16, v202
    v_and_b32 v141, 0xffff0000, v202
    v_mul_f32 v140, v140, v108
    v_mul_f32 v141, v141, v109
    v_mfma_f32_32x32x16_bf16 v[48:63], v[132:135], v[100:103], v[48:63]
    v_cvt_pk_bf16_f32 v130, v140, v141
    v_lshlrev_b32 v142, 16, v203
    v_and_b32 v143, 0xffff0000, v203
    v_mul_f32 v142, v142, v110
    v_mul_f32 v143, v143, v111
    v_cvt_pk_bf16_f32 v131, v142, v143
    v_mfma_f32_16x16x32_bf16 v[64:67], v[100:103], v[124:127], v[64:67]
    s_waitcnt lgkmcnt(0)
    ds_read_b64_tr_b16 v[92:93], v12 offset:9216
    ds_read_b64_tr_b16 v[94:95], v12 offset:9472
    ds_read_b64_tr_b16 v[96:97], v12 offset:10240
    ds_read_b64_tr_b16 v[98:99], v12 offset:10496
    ds_read_b64_tr_b16 v[100:101], v12 offset:11264
    ds_read_b64_tr_b16 v[102:103], v12 offset:11520
    ds_read_b128 v[124:127], v15 offset:96
    ds_read_b128 v[104:107], v14 offset:256
    ds_read_b128 v[108:111], v14 offset:272
    v_mfma_f32_32x32x16_bf16 v[16:31], v[80:83], v[128:131], v[16:31]
    v_lshlrev_b32 v136, 16, v204
    v_and_b32 v137, 0xffff0000, v204
    v_mul_f32 v136, v136, v112
    v_mul_f32 v137, v137, v113
    v_cvt_pk_bf16_f32 v132, v136, v137
    v_lshlrev_b32 v138, 16, v205
    v_and_b32 v139, 0xffff0000, v205
    v_mfma_f32_32x32x16_bf16 v[32:47], v[84:87], v[128:131], v[32:47]
    global_load_lds_dwordx4 v150, s[38:39] offset:2048
    v_mul_f32 v138, v138, v114
    v_mul_f32 v139, v139, v115
    v_cvt_pk_bf16_f32 v133, v138, v139
    v_lshlrev_b32 v140, 16, v206
    v_and_b32 v141, 0xffff0000, v206
    v_mul_f32 v140, v140, v116
    v_mul_f32 v141, v141, v117
    v_mfma_f32_32x32x16_bf16 v[48:63], v[128:131], v[88:91], v[48:63]
    v_cvt_pk_bf16_f32 v134, v140, v141
    v_lshlrev_b32 v142, 16, v207
    v_and_b32 v143, 0xffff0000, v207
    v_mul_f32 v142, v142, v118
    v_mul_f32 v143, v143, v119
    v_cvt_pk_bf16_f32 v135, v142, v143
    v_mfma_f32_16x16x32_bf16 v[64:67], v[88:91], v[120:123], v[64:67]
    s_waitcnt lgkmcnt(0)
    s_waitcnt vmcnt(3)
    s_barrier
    ds_read_b64_tr_b16 v[80:81], v13 offset:0
    ds_read_b64_tr_b16 v[82:83], v13 offset:256
    ds_read_b64_tr_b16 v[84:85], v13 offset:1024
    ds_read_b64_tr_b16 v[86:87], v13 offset:1280
    ds_read_b64_tr_b16 v[88:89], v13 offset:2048
    ds_read_b64_tr_b16 v[90:91], v13 offset:2304
    ds_read_b128 v[120:123], v15 offset:128
    ds_read_b128 v[112:115], v14 offset:320
    ds_read_b128 v[116:119], v14 offset:336
    v_mfma_f32_32x32x16_bf16 v[16:31], v[92:95], v[132:135], v[16:31]
    v_lshlrev_b32 v136, 16, v208
    v_and_b32 v137, 0xffff0000, v208
    v_mul_f32 v136, v136, v104
    v_mul_f32 v137, v137, v105
    v_cvt_pk_bf16_f32 v128, v136, v137
    v_lshlrev_b32 v138, 16, v209
    v_and_b32 v139, 0xffff0000, v209
    v_mfma_f32_32x32x16_bf16 v[32:47], v[96:99], v[132:135], v[32:47]
    s_add_u32 s38, s38, 196608
    s_addc_u32 s39, s39, 0
    s_add_u32 m0, m0, 12288
    s_nop 0
    global_load_lds_dwordx4 v150, s[38:39] offset:0
    v_mul_f32 v138, v138, v106
    v_mul_f32 v139, v139, v107
    v_cvt_pk_bf16_f32 v129, v138, v139
    v_lshlrev_b32 v140, 16, v210
    v_and_b32 v141, 0xffff0000, v210
    v_mul_f32 v140, v140, v108
    v_mul_f32 v141, v141, v109
    v_mfma_f32_32x32x16_bf16 v[48:63], v[132:135], v[100:103], v[48:63]
    v_cvt_pk_bf16_f32 v130, v140, v141
    v_lshlrev_b32 v142, 16, v211
    v_and_b32 v143, 0xffff0000, v211
    v_mul_f32 v142, v142, v110
    v_mul_f32 v143, v143, v111
    v_cvt_pk_bf16_f32 v131, v142, v143
    v_mfma_f32_16x16x32_bf16 v[64:67], v[100:103], v[124:127], v[64:67]
    s_waitcnt lgkmcnt(0)
    ds_read_b64_tr_b16 v[92:93], v13 offset:3072
    ds_read_b64_tr_b16 v[94:95], v13 offset:3328
    ds_read_b64_tr_b16 v[96:97], v13 offset:4096
    ds_read_b64_tr_b16 v[98:99], v13 offset:4352
    ds_read_b64_tr_b16 v[100:101], v13 offset:5120
    ds_read_b64_tr_b16 v[102:103], v13 offset:5376
    ds_read_b128 v[124:127], v15 offset:160
    ds_read_b128 v[104:107], v14 offset:384
    ds_read_b128 v[108:111], v14 offset:400
    v_mfma_f32_32x32x16_bf16 v[16:31], v[80:83], v[128:131], v[16:31]
    v_lshlrev_b32 v136, 16, v212
    v_and_b32 v137, 0xffff0000, v212
    v_mul_f32 v136, v136, v112
    v_mul_f32 v137, v137, v113
    v_cvt_pk_bf16_f32 v132, v136, v137
    v_lshlrev_b32 v138, 16, v213
    v_and_b32 v139, 0xffff0000, v213
    v_mfma_f32_32x32x16_bf16 v[32:47], v[84:87], v[128:131], v[32:47]
    global_load_lds_dwordx4 v150, s[38:39] offset:1024
    v_mul_f32 v138, v138, v114
    v_mul_f32 v139, v139, v115
    v_cvt_pk_bf16_f32 v133, v138, v139
    v_lshlrev_b32 v140, 16, v214
    v_and_b32 v141, 0xffff0000, v214
    v_mul_f32 v140, v140, v116
    v_mul_f32 v141, v141, v117
    v_mfma_f32_32x32x16_bf16 v[48:63], v[128:131], v[88:91], v[48:63]
    v_cvt_pk_bf16_f32 v134, v140, v141
    v_lshlrev_b32 v142, 16, v215
    v_and_b32 v143, 0xffff0000, v215
    v_mul_f32 v142, v142, v118
    v_mul_f32 v143, v143, v119
    v_cvt_pk_bf16_f32 v135, v142, v143
    v_mfma_f32_16x16x32_bf16 v[64:67], v[88:91], v[120:123], v[64:67]
    s_waitcnt lgkmcnt(0)
    ds_read_b64_tr_b16 v[80:81], v13 offset:6144
    ds_read_b64_tr_b16 v[82:83], v13 offset:6400
    ds_read_b64_tr_b16 v[84:85], v13 offset:7168
    ds_read_b64_tr_b16 v[86:87], v13 offset:7424
    ds_read_b64_tr_b16 v[88:89], v13 offset:8192
    ds_read_b64_tr_b16 v[90:91], v13 offset:8448
    ds_read_b128 v[120:123], v15 offset:192
    ds_read_b128 v[112:115], v14 offset:448
    ds_read_b128 v[116:119], v14 offset:464
    v_mfma_f32_32x32x16_bf16 v[16:31], v[92:95], v[132:135], v[16:31]
    v_lshlrev_b32 v136, 16, v216
    v_and_b32 v137, 0xffff0000, v216
    v_mul_f32 v136, v136, v104
    v_mul_f32 v137, v137, v105
    v_cvt_pk_bf16_f32 v128, v136, v137
    v_lshlrev_b32 v138, 16, v217
    v_and_b32 v139, 0xffff0000, v217
    v_mfma_f32_32x32x16_bf16 v[32:47], v[96:99], v[132:135], v[32:47]
    global_load_lds_dwordx4 v150, s[38:39] offset:2048
    v_mul_f32 v138, v138, v106
    v_mul_f32 v139, v139, v107
    v_cvt_pk_bf16_f32 v129, v138, v139
    v_lshlrev_b32 v140, 16, v218
    v_and_b32 v141, 0xffff0000, v218
    v_mul_f32 v140, v140, v108
    v_mul_f32 v141, v141, v109
    v_mfma_f32_32x32x16_bf16 v[48:63], v[132:135], v[100:103], v[48:63]
    v_cvt_pk_bf16_f32 v130, v140, v141
    v_lshlrev_b32 v142, 16, v219
    v_and_b32 v143, 0xffff0000, v219
    v_mul_f32 v142, v142, v110
    v_mul_f32 v143, v143, v111
    v_cvt_pk_bf16_f32 v131, v142, v143
    v_mfma_f32_16x16x32_bf16 v[64:67], v[100:103], v[124:127], v[64:67]
    s_waitcnt lgkmcnt(0)
    ds_read_b64_tr_b16 v[92:93], v13 offset:9216
    ds_read_b64_tr_b16 v[94:95], v13 offset:9472
    ds_read_b64_tr_b16 v[96:97], v13 offset:10240
    ds_read_b64_tr_b16 v[98:99], v13 offset:10496
    ds_read_b64_tr_b16 v[100:101], v13 offset:11264
    ds_read_b64_tr_b16 v[102:103], v13 offset:11520
    ds_read_b128 v[124:127], v15 offset:224
    ds_read_b128 v[104:107], v14 offset:512
    ds_read_b128 v[108:111], v14 offset:528
    v_mfma_f32_32x32x16_bf16 v[16:31], v[80:83], v[128:131], v[16:31]
    v_lshlrev_b32 v136, 16, v220
    v_and_b32 v137, 0xffff0000, v220
    v_mul_f32 v136, v136, v112
    v_mul_f32 v137, v137, v113
    v_cvt_pk_bf16_f32 v132, v136, v137
    v_lshlrev_b32 v138, 16, v221
    v_and_b32 v139, 0xffff0000, v221
    v_mfma_f32_32x32x16_bf16 v[32:47], v[84:87], v[128:131], v[32:47]
    v_mul_f32 v138, v138, v114
    v_mul_f32 v139, v139, v115
    v_cvt_pk_bf16_f32 v133, v138, v139
    v_lshlrev_b32 v140, 16, v222
    v_and_b32 v141, 0xffff0000, v222
    v_mul_f32 v140, v140, v116
    v_mul_f32 v141, v141, v117
    v_mfma_f32_32x32x16_bf16 v[48:63], v[128:131], v[88:91], v[48:63]
    v_cvt_pk_bf16_f32 v134, v140, v141
    v_lshlrev_b32 v142, 16, v223
    v_and_b32 v143, 0xffff0000, v223
    v_mul_f32 v142, v142, v118
    v_mul_f32 v143, v143, v119
    v_cvt_pk_bf16_f32 v135, v142, v143
    v_mfma_f32_16x16x32_bf16 v[64:67], v[88:91], v[120:123], v[64:67]
    s_waitcnt lgkmcnt(0)
    s_waitcnt vmcnt(3)
    s_barrier
    ds_read_b64_tr_b16 v[80:81], v13 offset:12288
    ds_read_b64_tr_b16 v[82:83], v13 offset:12544
    ds_read_b64_tr_b16 v[84:85], v13 offset:13312
    ds_read_b64_tr_b16 v[86:87], v13 offset:13568
    ds_read_b64_tr_b16 v[88:89], v13 offset:14336
    ds_read_b64_tr_b16 v[90:91], v13 offset:14592
    ds_read_b128 v[120:123], v15 offset:256
    ds_read_b128 v[112:115], v14 offset:576
    ds_read_b128 v[116:119], v14 offset:592
    v_mfma_f32_32x32x16_bf16 v[16:31], v[92:95], v[132:135], v[16:31]
    v_lshlrev_b32 v136, 16, v224
    v_and_b32 v137, 0xffff0000, v224
    v_mul_f32 v136, v136, v104
    v_mul_f32 v137, v137, v105
    v_cvt_pk_bf16_f32 v128, v136, v137
    v_lshlrev_b32 v138, 16, v225
    v_and_b32 v139, 0xffff0000, v225
    v_mfma_f32_32x32x16_bf16 v[32:47], v[96:99], v[132:135], v[32:47]
    v_mul_f32 v138, v138, v106
    v_mul_f32 v139, v139, v107
    v_cvt_pk_bf16_f32 v129, v138, v139
    v_lshlrev_b32 v140, 16, v226
    v_and_b32 v141, 0xffff0000, v226
    v_mul_f32 v140, v140, v108
    v_mul_f32 v141, v141, v109
    v_mfma_f32_32x32x16_bf16 v[48:63], v[132:135], v[100:103], v[48:63]
    v_cvt_pk_bf16_f32 v130, v140, v141
    v_lshlrev_b32 v142, 16, v227
    v_and_b32 v143, 0xffff0000, v227
    v_mul_f32 v142, v142, v110
    v_mul_f32 v143, v143, v111
    v_cvt_pk_bf16_f32 v131, v142, v143
    v_mfma_f32_16x16x32_bf16 v[64:67], v[100:103], v[124:127], v[64:67]
    s_waitcnt lgkmcnt(0)
    ds_read_b64_tr_b16 v[92:93], v13 offset:15360
    ds_read_b64_tr_b16 v[94:95], v13 offset:15616
    ds_read_b64_tr_b16 v[96:97], v13 offset:16384
    ds_read_b64_tr_b16 v[98:99], v13 offset:16640
    ds_read_b64_tr_b16 v[100:101], v13 offset:17408
    ds_read_b64_tr_b16 v[102:103], v13 offset:17664
    ds_read_b128 v[124:127], v15 offset:288
    ds_read_b128 v[104:107], v14 offset:640
    ds_read_b128 v[108:111], v14 offset:656
    v_mfma_f32_32x32x16_bf16 v[16:31], v[80:83], v[128:131], v[16:31]
    v_lshlrev_b32 v136, 16, v228
    v_and_b32 v137, 0xffff0000, v228
    v_mul_f32 v136, v136, v112
    v_mul_f32 v137, v137, v113
    v_cvt_pk_bf16_f32 v132, v136, v137
    v_lshlrev_b32 v138, 16, v229
    v_and_b32 v139, 0xffff0000, v229
    v_mfma_f32_32x32x16_bf16 v[32:47], v[84:87], v[128:131], v[32:47]
    v_mul_f32 v138, v138, v114
    v_mul_f32 v139, v139, v115
    v_cvt_pk_bf16_f32 v133, v138, v139
    v_lshlrev_b32 v140, 16, v230
    v_and_b32 v141, 0xffff0000, v230
    v_mul_f32 v140, v140, v116
    v_mul_f32 v141, v141, v117
    v_mfma_f32_32x32x16_bf16 v[48:63], v[128:131], v[88:91], v[48:63]
    v_cvt_pk_bf16_f32 v134, v140, v141
    v_lshlrev_b32 v142, 16, v231
    v_and_b32 v143, 0xffff0000, v231
    v_mul_f32 v142, v142, v118
    v_mul_f32 v143, v143, v119
    v_cvt_pk_bf16_f32 v135, v142, v143
    v_mfma_f32_16x16x32_bf16 v[64:67], v[88:91], v[120:123], v[64:67]
    s_waitcnt lgkmcnt(0)
    ds_read_b64_tr_b16 v[80:81], v13 offset:18432
    ds_read_b64_tr_b16 v[82:83], v13 offset:18688
    ds_read_b64_tr_b16 v[84:85], v13 offset:19456
    ds_read_b64_tr_b16 v[86:87], v13 offset:19712
    ds_read_b64_tr_b16 v[88:89], v13 offset:20480
    ds_read_b64_tr_b16 v[90:91], v13 offset:20736
    ds_read_b128 v[120:123], v15 offset:320
    ds_read_b128 v[112:115], v14 offset:704
    ds_read_b128 v[116:119], v14 offset:720
    v_mfma_f32_32x32x16_bf16 v[16:31], v[92:95], v[132:135], v[16:31]
    v_lshlrev_b32 v136, 16, v232
    v_and_b32 v137, 0xffff0000, v232
    v_mul_f32 v136, v136, v104
    v_mul_f32 v137, v137, v105
    v_cvt_pk_bf16_f32 v128, v136, v137
    v_lshlrev_b32 v138, 16, v233
    v_and_b32 v139, 0xffff0000, v233
    v_mfma_f32_32x32x16_bf16 v[32:47], v[96:99], v[132:135], v[32:47]
    v_mul_f32 v138, v138, v106
    v_mul_f32 v139, v139, v107
    v_cvt_pk_bf16_f32 v129, v138, v139
    v_lshlrev_b32 v140, 16, v234
    v_and_b32 v141, 0xffff0000, v234
    v_mul_f32 v140, v140, v108
    v_mul_f32 v141, v141, v109
    v_mfma_f32_32x32x16_bf16 v[48:63], v[132:135], v[100:103], v[48:63]
    v_cvt_pk_bf16_f32 v130, v140, v141
    v_lshlrev_b32 v142, 16, v235
    v_and_b32 v143, 0xffff0000, v235
    v_mul_f32 v142, v142, v110
    v_mul_f32 v143, v143, v111
    v_cvt_pk_bf16_f32 v131, v142, v143
    v_mfma_f32_16x16x32_bf16 v[64:67], v[100:103], v[124:127], v[64:67]
    s_waitcnt lgkmcnt(0)
    ds_read_b64_tr_b16 v[92:93], v13 offset:21504
    ds_read_b64_tr_b16 v[94:95], v13 offset:21760
    ds_read_b64_tr_b16 v[96:97], v13 offset:22528
    ds_read_b64_tr_b16 v[98:99], v13 offset:22784
    ds_read_b64_tr_b16 v[100:101], v13 offset:23552
    ds_read_b64_tr_b16 v[102:103], v13 offset:23808
    ds_read_b128 v[124:127], v15 offset:352
    ds_read_b128 v[104:107], v14 offset:768
    ds_read_b128 v[108:111], v14 offset:784
    v_mfma_f32_32x32x16_bf16 v[16:31], v[80:83], v[128:131], v[16:31]
    v_lshlrev_b32 v136, 16, v236
    v_and_b32 v137, 0xffff0000, v236
    v_mul_f32 v136, v136, v112
    v_mul_f32 v137, v137, v113
    v_cvt_pk_bf16_f32 v132, v136, v137
    v_lshlrev_b32 v138, 16, v237
    v_and_b32 v139, 0xffff0000, v237
    v_mfma_f32_32x32x16_bf16 v[32:47], v[84:87], v[128:131], v[32:47]
    v_mul_f32 v138, v138, v114
    v_mul_f32 v139, v139, v115
    v_cvt_pk_bf16_f32 v133, v138, v139
    v_lshlrev_b32 v140, 16, v238
    v_and_b32 v141, 0xffff0000, v238
    v_mul_f32 v140, v140, v116
    v_mul_f32 v141, v141, v117
    v_mfma_f32_32x32x16_bf16 v[48:63], v[128:131], v[88:91], v[48:63]
    v_cvt_pk_bf16_f32 v134, v140, v141
    v_lshlrev_b32 v142, 16, v239
    v_and_b32 v143, 0xffff0000, v239
    v_mul_f32 v142, v142, v118
    v_mul_f32 v143, v143, v119
    v_cvt_pk_bf16_f32 v135, v142, v143
    v_mfma_f32_16x16x32_bf16 v[64:67], v[88:91], v[120:123], v[64:67]
    s_waitcnt lgkmcnt(0)
    s_waitcnt vmcnt(0)
    s_barrier
    global_load_dwordx4 v[4:7], v11, s[24:25] sc1
    ds_read_b64_tr_b16 v[80:81], v13 offset:24576
    ds_read_b64_tr_b16 v[82:83], v13 offset:24832
    ds_read_b64_tr_b16 v[84:85], v13 offset:25600
    ds_read_b64_tr_b16 v[86:87], v13 offset:25856
    ds_read_b64_tr_b16 v[88:89], v13 offset:26624
    ds_read_b64_tr_b16 v[90:91], v13 offset:26880
    ds_read_b128 v[120:123], v15 offset:384
    ds_read_b128 v[112:115], v14 offset:832
    ds_read_b128 v[116:119], v14 offset:848
    v_mfma_f32_32x32x16_bf16 v[16:31], v[92:95], v[132:135], v[16:31]
    v_lshlrev_b32 v136, 16, v240
    v_and_b32 v137, 0xffff0000, v240
    v_mul_f32 v136, v136, v104
    v_mul_f32 v137, v137, v105
    v_cvt_pk_bf16_f32 v128, v136, v137
    v_lshlrev_b32 v138, 16, v241
    v_and_b32 v139, 0xffff0000, v241
    v_mfma_f32_32x32x16_bf16 v[32:47], v[96:99], v[132:135], v[32:47]
    v_mul_f32 v138, v138, v106
    v_mul_f32 v139, v139, v107
    v_cvt_pk_bf16_f32 v129, v138, v139
    v_lshlrev_b32 v140, 16, v242
    v_and_b32 v141, 0xffff0000, v242
    v_mul_f32 v140, v140, v108
    v_mul_f32 v141, v141, v109
    v_mfma_f32_32x32x16_bf16 v[48:63], v[132:135], v[100:103], v[48:63]
    v_cvt_pk_bf16_f32 v130, v140, v141
    v_lshlrev_b32 v142, 16, v243
    v_and_b32 v143, 0xffff0000, v243
    v_mul_f32 v142, v142, v110
    v_mul_f32 v143, v143, v111
    v_cvt_pk_bf16_f32 v131, v142, v143
    v_mfma_f32_16x16x32_bf16 v[64:67], v[100:103], v[124:127], v[64:67]
    s_waitcnt lgkmcnt(0)
    ds_read_b64_tr_b16 v[92:93], v13 offset:27648
    ds_read_b64_tr_b16 v[94:95], v13 offset:27904
    ds_read_b64_tr_b16 v[96:97], v13 offset:28672
    ds_read_b64_tr_b16 v[98:99], v13 offset:28928
    ds_read_b64_tr_b16 v[100:101], v13 offset:29696
    ds_read_b64_tr_b16 v[102:103], v13 offset:29952
    ds_read_b128 v[124:127], v15 offset:416
    ds_read_b128 v[104:107], v14 offset:896
    ds_read_b128 v[108:111], v14 offset:912
    v_mfma_f32_32x32x16_bf16 v[16:31], v[80:83], v[128:131], v[16:31]
    v_lshlrev_b32 v136, 16, v244
    v_and_b32 v137, 0xffff0000, v244
    v_mul_f32 v136, v136, v112
    v_mul_f32 v137, v137, v113
    v_cvt_pk_bf16_f32 v132, v136, v137
    v_lshlrev_b32 v138, 16, v245
    v_and_b32 v139, 0xffff0000, v245
    v_mfma_f32_32x32x16_bf16 v[32:47], v[84:87], v[128:131], v[32:47]
    v_mul_f32 v138, v138, v114
    v_mul_f32 v139, v139, v115
    v_cvt_pk_bf16_f32 v133, v138, v139
    v_lshlrev_b32 v140, 16, v246
    v_and_b32 v141, 0xffff0000, v246
    v_mul_f32 v140, v140, v116
    v_mul_f32 v141, v141, v117
    v_mfma_f32_32x32x16_bf16 v[48:63], v[128:131], v[88:91], v[48:63]
    v_cvt_pk_bf16_f32 v134, v140, v141
    v_lshlrev_b32 v142, 16, v247
    v_and_b32 v143, 0xffff0000, v247
    v_mul_f32 v142, v142, v118
    v_mul_f32 v143, v143, v119
    v_cvt_pk_bf16_f32 v135, v142, v143
    v_mfma_f32_16x16x32_bf16 v[64:67], v[88:91], v[120:123], v[64:67]
    s_waitcnt lgkmcnt(0)
    ds_read_b64_tr_b16 v[80:81], v13 offset:30720
    ds_read_b64_tr_b16 v[82:83], v13 offset:30976
    ds_read_b64_tr_b16 v[84:85], v13 offset:31744
    ds_read_b64_tr_b16 v[86:87], v13 offset:32000
    ds_read_b64_tr_b16 v[88:89], v13 offset:32768
    ds_read_b64_tr_b16 v[90:91], v13 offset:33024
    ds_read_b128 v[120:123], v15 offset:448
    ds_read_b128 v[112:115], v14 offset:960
    ds_read_b128 v[116:119], v14 offset:976
    v_mfma_f32_32x32x16_bf16 v[16:31], v[92:95], v[132:135], v[16:31]
    v_lshlrev_b32 v136, 16, v248
    v_and_b32 v137, 0xffff0000, v248
    v_mul_f32 v136, v136, v104
    v_mul_f32 v137, v137, v105
    v_cvt_pk_bf16_f32 v128, v136, v137
    v_lshlrev_b32 v138, 16, v249
    v_and_b32 v139, 0xffff0000, v249
    v_mfma_f32_32x32x16_bf16 v[32:47], v[96:99], v[132:135], v[32:47]
    v_mul_f32 v138, v138, v106
    v_mul_f32 v139, v139, v107
    v_cvt_pk_bf16_f32 v129, v138, v139
    v_lshlrev_b32 v140, 16, v250
    v_and_b32 v141, 0xffff0000, v250
    v_mul_f32 v140, v140, v108
    v_mul_f32 v141, v141, v109
    v_mfma_f32_32x32x16_bf16 v[48:63], v[132:135], v[100:103], v[48:63]
    v_cvt_pk_bf16_f32 v130, v140, v141
    v_lshlrev_b32 v142, 16, v251
    v_and_b32 v143, 0xffff0000, v251
    v_mul_f32 v142, v142, v110
    v_mul_f32 v143, v143, v111
    v_cvt_pk_bf16_f32 v131, v142, v143
    v_mfma_f32_16x16x32_bf16 v[64:67], v[100:103], v[124:127], v[64:67]
    s_waitcnt lgkmcnt(0)
    ds_read_b64_tr_b16 v[92:93], v13 offset:33792
    ds_read_b64_tr_b16 v[94:95], v13 offset:34048
    ds_read_b64_tr_b16 v[96:97], v13 offset:34816
    ds_read_b64_tr_b16 v[98:99], v13 offset:35072
    ds_read_b64_tr_b16 v[100:101], v13 offset:35840
    ds_read_b64_tr_b16 v[102:103], v13 offset:36096
    ds_read_b128 v[124:127], v15 offset:480
    v_mfma_f32_32x32x16_bf16 v[16:31], v[80:83], v[128:131], v[16:31]
    v_lshlrev_b32 v136, 16, v252
    v_and_b32 v137, 0xffff0000, v252
    v_mul_f32 v136, v136, v112
    v_mul_f32 v137, v137, v113
    v_cvt_pk_bf16_f32 v132, v136, v137
    v_lshlrev_b32 v138, 16, v253
    v_and_b32 v139, 0xffff0000, v253
    v_mfma_f32_32x32x16_bf16 v[32:47], v[84:87], v[128:131], v[32:47]
    v_mul_f32 v138, v138, v114
    v_mul_f32 v139, v139, v115
    v_cvt_pk_bf16_f32 v133, v138, v139
    v_lshlrev_b32 v140, 16, v254
    v_and_b32 v141, 0xffff0000, v254
    v_mul_f32 v140, v140, v116
    v_mul_f32 v141, v141, v117
    v_mfma_f32_32x32x16_bf16 v[48:63], v[128:131], v[88:91], v[48:63]
    v_cvt_pk_bf16_f32 v134, v140, v141
    v_lshlrev_b32 v142, 16, v255
    v_and_b32 v143, 0xffff0000, v255
    v_mul_f32 v142, v142, v118
    v_mul_f32 v143, v143, v119
    v_cvt_pk_bf16_f32 v135, v142, v143
    v_mfma_f32_16x16x32_bf16 v[64:67], v[88:91], v[120:123], v[64:67]
    s_waitcnt lgkmcnt(0)
    v_mfma_f32_32x32x16_bf16 v[16:31], v[92:95], v[132:135], v[16:31]
    v_mfma_f32_32x32x16_bf16 v[32:47], v[96:99], v[132:135], v[32:47]
    v_mfma_f32_32x32x16_bf16 v[48:63], v[132:135], v[100:103], v[48:63]
    v_mfma_f32_16x16x32_bf16 v[64:67], v[100:103], v[124:127], v[64:67]
    s_branch L_lpend
L_lpv3:
    ds_read_b128 v[104:107], v14 offset:0
    ds_read_b128 v[108:111], v14 offset:16
    ds_read_b64_tr_b16 v[80:81], v12 offset:0
    ds_read_b64_tr_b16 v[82:83], v12 offset:256
    ds_read_b64_tr_b16 v[84:85], v12 offset:1024
    ds_read_b64_tr_b16 v[86:87], v12 offset:1280
    ds_read_b64_tr_b16 v[88:89], v12 offset:2048
    ds_read_b64_tr_b16 v[90:91], v12 offset:2304
    ds_read_b128 v[112:115], v14 offset:64
    ds_read_b128 v[116:119], v14 offset:80
    s_waitcnt lgkmcnt(8)
    v_lshlrev_b32 v136, 16, v192
    v_and_b32 v137, 0xffff0000, v192
    v_mul_f32 v136, v136, v104
    v_mul_f32 v137, v137, v105
    v_cvt_pk_bf16_f32 v128, v136, v137
    v_lshlrev_b32 v138, 16, v193
    v_and_b32 v139, 0xffff0000, v193
    v_mul_f32 v138, v138, v106
    v_mul_f32 v139, v139, v107
    v_cvt_pk_bf16_f32 v129, v138, v139
    v_lshlrev_b32 v140, 16, v194
    v_and_b32 v141, 0xffff0000, v194
    v_mul_f32 v140, v140, v108
    v_mul_f32 v141, v141, v109
    v_cvt_pk_bf16_f32 v130, v140, v141
    v_lshlrev_b32 v142, 16, v195
    v_and_b32 v143, 0xffff0000, v195
    v_mul_f32 v142, v142, v110
    v_mul_f32 v143, v143, v111
    v_cvt_pk_bf16_f32 v131, v142, v143
    s_waitcnt lgkmcnt(0)
    ds_read_b64_tr_b16 v[92:93], v12 offset:3072
    ds_read_b64_tr_b16 v[94:95], v12 offset:3328
    ds_read_b64_tr_b16 v[96:97], v12 offset:4096
    ds_read_b64_tr_b16 v[98:99], v12 offset:4352
    ds_read_b64_tr_b16 v[100:101], v12 offset:5120
    ds_read_b64_tr_b16 v[102:103], v12 offset:5376
    ds_read_b128 v[104:107], v14 offset:128
    ds_read_b128 v[108:111], v14 offset:144
    s_nop 1
    v_mfma_f32_32x32x16_bf16 v[16:31], v[80:83], v[128:131], v[16:31]
    v_lshlrev_b32 v136, 16, v196
    v_and_b32 v137, 0xffff0000, v196
    v_mul_f32 v136, v136, v112
    v_mul_f32 v137, v137, v113
    v_cvt_pk_bf16_f32 v132, v136, v137
    v_lshlrev_b32 v138, 16, v197
    v_and_b32 v139, 0xffff0000, v197
    v_mfma_f32_32x32x16_bf16 v[32:47], v[84:87], v[128:131], v[32:47]
    global_load_lds_dwordx4 v150, s[38:39] offset:0
    v_mul_f32 v138, v138, v114
    v_mul_f32 v139, v139, v115
    v_cvt_pk_bf16_f32 v133, v138, v139
    v_lshlrev_b32 v140, 16, v198
    v_and_b32 v141, 0xffff0000, v198
    v_mul_f32 v140, v140, v116
    v_mul_f32 v141, v141, v117
    v_mfma_f32_32x32x16_bf16 v[48:63], v[128:131], v[88:91], v[48:63]
    v_cvt_pk_bf16_f32 v134, v140, v141
    v_lshlrev_b32 v142, 16, v199
    v_and_b32 v143, 0xffff0000, v199
    v_mul_f32 v142, v142, v118
    v_mul_f32 v143, v143, v119
    v_cvt_pk_bf16_f32 v135, v142, v143
    s_waitcnt lgkmcnt(0)
    ds_read_b64_tr_b16 v[80:81], v12 offset:6144
    ds_read_b64_tr_b16 v[82:83], v12 offset:6400
    ds_read_b64_tr_b16 v[84:85], v12 offset:7168
    ds_read_b64_tr_b16 v[86:87], v12 offset:7424
    ds_read_b64_tr_b16 v[88:89], v12 offset:8192
    ds_read_b64_tr_b16 v[90:91], v12 offset:8448
    ds_read_b128 v[112:115], v14 offset:192
    ds_read_b128 v[116:119], v14 offset:208
    v_mfma_f32_32x32x16_bf16 v[16:31], v[92:95], v[132:135], v[16:31]
    v_lshlrev_b32 v136, 16, v200
    v_and_b32 v137, 0xffff0000, v200
    v_mul_f32 v136, v136, v104
    v_mul_f32 v137, v137, v105
    v_cvt_pk_bf16_f32 v128, v136, v137
    v_lshlrev_b32 v138, 16, v201
    v_and_b32 v139, 0xffff0000, v201
    v_mfma_f32_32x32x16_bf16 v[32:47], v[96:99], v[132:135], v[32:47]
    global_load_lds_dwordx4 v150, s[38:39] offset:1024
    v_mul_f32 v138, v138, v106
    v_mul_f32 v139, v139, v107
    v_cvt_pk_bf16_f32 v129, v138, v139
    v_lshlrev_b32 v140, 16, v202
    v_and_b32 v141, 0xffff0000, v202
    v_mul_f32 v140, v140, v108
    v_mul_f32 v141, v141, v109
    v_mfma_f32_32x32x16_bf16 v[48:63], v[132:135], v[100:103], v[48:63]
    v_cvt_pk_bf16_f32 v130, v140, v141
    v_lshlrev_b32 v142, 16, v203
    v_and_b32 v143, 0xffff0000, v203
    v_mul_f32 v142, v142, v110
    v_mul_f32 v143, v143, v111
    v_cvt_pk_bf16_f32 v131, v142, v143
    s_waitcnt lgkmcnt(0)
    ds_read_b64_tr_b16 v[92:93], v12 offset:9216
    ds_read_b64_tr_b16 v[94:95], v12 offset:9472
    ds_read_b64_tr_b16 v[96:97], v12 offset:10240
    ds_read_b64_tr_b16 v[98:99], v12 offset:10496
    ds_read_b64_tr_b16 v[100:101], v12 offset:11264
    ds_read_b64_tr_b16 v[102:103], v12 offset:11520
    ds_read_b128 v[104:107], v14 offset:256
    ds_read_b128 v[108:111], v14 offset:272
    v_mfma_f32_32x32x16_bf16 v[16:31], v[80:83], v[128:131], v[16:31]
    v_lshlrev_b32 v136, 16, v204
    v_and_b32 v137, 0xffff0000, v204
    v_mul_f32 v136, v136, v112
    v_mul_f32 v137, v137, v113
    v_cvt_pk_bf16_f32 v132, v136, v137
    v_lshlrev_b32 v138, 16, v205
    v_and_b32 v139, 0xffff0000, v205
    v_mfma_f32_32x32x16_bf16 v[32:47], v[84:87], v[128:131], v[32:47]
    global_load_lds_dwordx4 v150, s[38:39] offset:2048
    v_mul_f32 v138, v138, v114
    v_mul_f32 v139, v139, v115
    v_cvt_pk_bf16_f32 v133, v138, v139
    v_lshlrev_b32 v140, 16, v206
    v_and_b32 v141, 0xffff0000, v206
    v_mul_f32 v140, v140, v116
    v_mul_f32 v141, v141, v117
    v_mfma_f32_32x32x16_bf16 v[48:63], v[128:131], v[88:91], v[48:63]
    v_cvt_pk_bf16_f32 v134, v140, v141
    v_lshlrev_b32 v142, 16, v207
    v_and_b32 v143, 0xffff0000, v207
    v_mul_f32 v142, v142, v118
    v_mul_f32 v143, v143, v119
    v_cvt_pk_bf16_f32 v135, v142, v143
    s_waitcnt lgkmcnt(0)
    s_waitcnt vmcnt(3)
    s_barrier
    ds_read_b64_tr_b16 v[80:81], v13 offset:0
    ds_read_b64_tr_b16 v[82:83], v13 offset:256
    ds_read_b64_tr_b16 v[84:85], v13 offset:1024
    ds_read_b64_tr_b16 v[86:87], v13 offset:1280
    ds_read_b64_tr_b16 v[88:89], v13 offset:2048
    ds_read_b64_tr_b16 v[90:91], v13 offset:2304
    ds_read_b128 v[112:115], v14 offset:320
    ds_read_b128 v[116:119], v14 offset:336
    v_mfma_f32_32x32x16_bf16 v[16:31], v[92:95], v[132:135], v[16:31]
    v_lshlrev_b32 v136, 16, v208
    v_and_b32 v137, 0xffff0000, v208
    v_mul_f32 v136, v136, v104
    v_mul_f32 v137, v137, v105
    v_cvt_pk_bf16_f32 v128, v136, v137
    v_lshlrev_b32 v138, 16, v209
    v_and_b32 v139, 0xffff0000, v209
    v_mfma_f32_32x32x16_bf16 v[32:47], v[96:99], v[132:135], v[32:47]
    s_add_u32 s38, s38, 196608
    s_addc_u32 s39, s39, 0
    s_add_u32 m0, m0, 12288
    s_nop 0
    global_load_lds_dwordx4 v150, s[38:39] offset:0
    v_mul_f32 v138, v138, v106
    v_mul_f32 v139, v139, v107
    v_cvt_pk_bf16_f32 v129, v138, v139
    v_lshlrev_b32 v140, 16, v210
    v_and_b32 v141, 0xffff0000, v210
    v_mul_f32 v140, v140, v108
    v_mul_f32 v141, v141, v109
    v_mfma_f32_32x32x16_bf16 v[48:63], v[132:135], v[100:103], v[48:63]
    v_cvt_pk_bf16_f32 v130, v140, v141
    v_lshlrev_b32 v142, 16, v211
    v_and_b32 v143, 0xffff0000, v211
    v_mul_f32 v142, v142, v110
    v_mul_f32 v143, v143, v111
    v_cvt_pk_bf16_f32 v131, v142, v143
    s_waitcnt lgkmcnt(0)
    ds_read_b64_tr_b16 v[92:93], v13 offset:3072
    ds_read_b64_tr_b16 v[94:95], v13 offset:3328
    ds_read_b64_tr_b16 v[96:97], v13 offset:4096
    ds_read_b64_tr_b16 v[98:99], v13 offset:4352
    ds_read_b64_tr_b16 v[100:101], v13 offset:5120
    ds_read_b64_tr_b16 v[102:103], v13 offset:5376
    ds_read_b128 v[104:107], v14 offset:384
    ds_read_b128 v[108:111], v14 offset:400
    v_mfma_f32_32x32x16_bf16 v[16:31], v[80:83], v[128:131], v[16:31]
    v_lshlrev_b32 v136, 16, v212
    v_and_b32 v137, 0xffff0000, v212
    v_mul_f32 v136, v136, v112
    v_mul_f32 v137, v137, v113
    v_cvt_pk_bf16_f32 v132, v136, v137
    v_lshlrev_b32 v138, 16, v213
    v_and_b32 v139, 0xffff0000, v213
    v_mfma_f32_32x32x16_bf16 v[32:47], v[84:87], v[128:131], v[32:47]
    global_load_lds_dwordx4 v150, s[38:39] offset:1024
    v_mul_f32 v138, v138, v114
    v_mul_f32 v139, v139, v115
    v_cvt_pk_bf16_f32 v133, v138, v139
    v_lshlrev_b32 v140, 16, v214
    v_and_b32 v141, 0xffff0000, v214
    v_mul_f32 v140, v140, v116
    v_mul_f32 v141, v141, v117
    v_mfma_f32_32x32x16_bf16 v[48:63], v[128:131], v[88:91], v[48:63]
    v_cvt_pk_bf16_f32 v134, v140, v141
    v_lshlrev_b32 v142, 16, v215
    v_and_b32 v143, 0xffff0000, v215
    v_mul_f32 v142, v142, v118
    v_mul_f32 v143, v143, v119
    v_cvt_pk_bf16_f32 v135, v142, v143
    s_waitcnt lgkmcnt(0)
    ds_read_b64_tr_b16 v[80:81], v13 offset:6144
    ds_read_b64_tr_b16 v[82:83], v13 offset:6400
    ds_read_b64_tr_b16 v[84:85], v13 offset:7168
    ds_read_b64_tr_b16 v[86:87], v13 offset:7424
    ds_read_b64_tr_b16 v[88:89], v13 offset:8192
    ds_read_b64_tr_b16 v[90:91], v13 offset:8448
    ds_read_b128 v[112:115], v14 offset:448
    ds_read_b128 v[116:119], v14 offset:464
    v_mfma_f32_32x32x16_bf16 v[16:31], v[92:95], v[132:135], v[16:31]
    v_lshlrev_b32 v136, 16, v216
    v_and_b32 v137, 0xffff0000, v216
    v_mul_f32 v136, v136, v104
    v_mul_f32 v137, v137, v105
    v_cvt_pk_bf16_f32 v128, v136, v137
    v_lshlrev_b32 v138, 16, v217
    v_and_b32 v139, 0xffff0000, v217
    v_mfma_f32_32x32x16_bf16 v[32:47], v[96:99], v[132:135], v[32:47]
    global_load_lds_dwordx4 v150, s[38:39] offset:2048
    v_mul_f32 v138, v138, v106
    v_mul_f32 v139, v139, v107
    v_cvt_pk_bf16_f32 v129, v138, v139
    v_lshlrev_b32 v140, 16, v218
    v_and_b32 v141, 0xffff0000, v218
    v_mul_f32 v140, v140, v108
    v_mul_f32 v141, v141, v109
    v_mfma_f32_32x32x16_bf16 v[48:63], v[132:135], v[100:103], v[48:63]
    v_cvt_pk_bf16_f32 v130, v140, v141
    v_lshlrev_b32 v142, 16, v219
    v_and_b32 v143, 0xffff0000, v219
    v_mul_f32 v142, v142, v110
    v_mul_f32 v143, v143, v111
    v_cvt_pk_bf16_f32 v131, v142, v143
    s_waitcnt lgkmcnt(0)
    ds_read_b64_tr_b16 v[92:93], v13 offset:9216
    ds_read_b64_tr_b16 v[94:95], v13 offset:9472
    ds_read_b64_tr_b16 v[96:97], v13 offset:10240
    ds_read_b64_tr_b16 v[98:99], v13 offset:10496
    ds_read_b64_tr_b16 v[100:101], v13 offset:11264
    ds_read_b64_tr_b16 v[102:103], v13 offset:11520
    ds_read_b128 v[104:107], v14 offset:512
    ds_read_b128 v[108:111], v14 offset:528
    v_mfma_f32_32x32x16_bf16 v[16:31], v[80:83], v[128:131], v[16:31]
    v_lshlrev_b32 v136, 16, v220
    v_and_b32 v137, 0xffff0000, v220
    v_mul_f32 v136, v136, v112
    v_mul_f32 v137, v137, v113
    v_cvt_pk_bf16_f32 v132, v136, v137
    v_lshlrev_b32 v138, 16, v221
    v_and_b32 v139, 0xffff0000, v221
    v_mfma_f32_32x32x16_bf16 v[32:47], v[84:87], v[128:131], v[32:47]
    v_mul_f32 v138, v138, v114
    v_mul_f32 v139, v139, v115
    v_cvt_pk_bf16_f32 v133, v138, v139
    v_lshlrev_b32 v140, 16, v222
    v_and_b32 v141, 0xffff0000, v222
    v_mul_f32 v140, v140, v116
    v_mul_f32 v141, v141, v117
    v_mfma_f32_32x32x16_bf16 v[48:63], v[128:131], v[88:91], v[48:63]
    v_cvt_pk_bf16_f32 v134, v140, v141
    v_lshlrev_b32 v142, 16, v223
    v_and_b32 v143, 0xffff0000, v223
    v_mul_f32 v142, v142, v118
    v_mul_f32 v143, v143, v119
    v_cvt_pk_bf16_f32 v135, v142, v143
    s_waitcnt lgkmcnt(0)
    s_waitcnt vmcnt(3)
    s_barrier
    ds_read_b64_tr_b16 v[80:81], v13 offset:12288
    ds_read_b64_tr_b16 v[82:83], v13 offset:12544
    ds_read_b64_tr_b16 v[84:85], v13 offset:13312
    ds_read_b64_tr_b16 v[86:87], v13 offset:13568
    ds_read_b64_tr_b16 v[88:89], v13 offset:14336
    ds_read_b64_tr_b16 v[90:91], v13 offset:14592
    ds_read_b128 v[112:115], v14 offset:576
    ds_read_b128 v[116:119], v14 offset:592
    v_mfma_f32_32x32x16_bf16 v[16:31], v[92:95], v[132:135], v[16:31]
    v_lshlrev_b32 v136, 16, v224
    v_and_b32 v137, 0xffff0000, v224
    v_mul_f32 v136, v136, v104
    v_mul_f32 v137, v137, v105
    v_cvt_pk_bf16_f32 v128, v136, v137
    v_lshlrev_b32 v138, 16, v225
    v_and_b32 v139, 0xffff0000, v225
    v_mfma_f32_32x32x16_bf16 v[32:47], v[96:99], v[132:135], v[32:47]
    v_mul_f32 v138, v138, v106
    v_mul_f32 v139, v139, v107
    v_cvt_pk_bf16_f32 v129, v138, v139
    v_lshlrev_b32 v140, 16, v226
    v_and_b32 v141, 0xffff0000, v226
    v_mul_f32 v140, v140, v108
    v_mul_f32 v141, v141, v109
    v_mfma_f32_32x32x16_bf16 v[48:63], v[132:135], v[100:103], v[48:63]
    v_cvt_pk_bf16_f32 v130, v140, v141
    v_lshlrev_b32 v142, 16, v227
    v_and_b32 v143, 0xffff0000, v227
    v_mul_f32 v142, v142, v110
    v_mul_f32 v143, v143, v111
    v_cvt_pk_bf16_f32 v131, v142, v143
    s_waitcnt lgkmcnt(0)
    ds_read_b64_tr_b16 v[92:93], v13 offset:15360
    ds_read_b64_tr_b16 v[94:95], v13 offset:15616
    ds_read_b64_tr_b16 v[96:97], v13 offset:16384
    ds_read_b64_tr_b16 v[98:99], v13 offset:16640
    ds_read_b64_tr_b16 v[100:101], v13 offset:17408
    ds_read_b64_tr_b16 v[102:103], v13 offset:17664
    ds_read_b128 v[104:107], v14 offset:640
    ds_read_b128 v[108:111], v14 offset:656
    v_mfma_f32_32x32x16_bf16 v[16:31], v[80:83], v[128:131], v[16:31]
    v_lshlrev_b32 v136, 16, v228
    v_and_b32 v137, 0xffff0000, v228
    v_mul_f32 v136, v136, v112
    v_mul_f32 v137, v137, v113
    v_cvt_pk_bf16_f32 v132, v136, v137
    v_lshlrev_b32 v138, 16, v229
    v_and_b32 v139, 0xffff0000, v229
    v_mfma_f32_32x32x16_bf16 v[32:47], v[84:87], v[128:131], v[32:47]
    v_mul_f32 v138, v138, v114
    v_mul_f32 v139, v139, v115
    v_cvt_pk_bf16_f32 v133, v138, v139
    v_lshlrev_b32 v140, 16, v230
    v_and_b32 v141, 0xffff0000, v230
    v_mul_f32 v140, v140, v116
    v_mul_f32 v141, v141, v117
    v_mfma_f32_32x32x16_bf16 v[48:63], v[128:131], v[88:91], v[48:63]
    v_cvt_pk_bf16_f32 v134, v140, v141
    v_lshlrev_b32 v142, 16, v231
    v_and_b32 v143, 0xffff0000, v231
    v_mul_f32 v142, v142, v118
    v_mul_f32 v143, v143, v119
    v_cvt_pk_bf16_f32 v135, v142, v143
    s_waitcnt lgkmcnt(0)
    ds_read_b64_tr_b16 v[80:81], v13 offset:18432
    ds_read_b64_tr_b16 v[82:83], v13 offset:18688
    ds_read_b64_tr_b16 v[84:85], v13 offset:19456
    ds_read_b64_tr_b16 v[86:87], v13 offset:19712
    ds_read_b64_tr_b16 v[88:89], v13 offset:20480
    ds_read_b64_tr_b16 v[90:91], v13 offset:20736
    ds_read_b128 v[112:115], v14 offset:704
    ds_read_b128 v[116:119], v14 offset:720
    v_mfma_f32_32x32x16_bf16 v[16:31], v[92:95], v[132:135], v[16:31]
    v_lshlrev_b32 v136, 16, v232
    v_and_b32 v137, 0xffff0000, v232
    v_mul_f32 v136, v136, v104
    v_mul_f32 v137, v137, v105
    v_cvt_pk_bf16_f32 v128, v136, v137
    v_lshlrev_b32 v138, 16, v233
    v_and_b32 v139, 0xffff0000, v233
    v_mfma_f32_32x32x16_bf16 v[32:47], v[96:99], v[132:135], v[32:47]
    v_mul_f32 v138, v138, v106
    v_mul_f32 v139, v139, v107
    v_cvt_pk_bf16_f32 v129, v138, v139
    v_lshlrev_b32 v140, 16, v234
    v_and_b32 v141, 0xffff0000, v234
    v_mul_f32 v140, v140, v108
    v_mul_f32 v141, v141, v109
    v_mfma_f32_32x32x16_bf16 v[48:63], v[132:135], v[100:103], v[48:63]
    v_cvt_pk_bf16_f32 v130, v140, v141
    v_lshlrev_b32 v142, 16, v235
    v_and_b32 v143, 0xffff0000, v235
    v_mul_f32 v142, v142, v110
    v_mul_f32 v143, v143, v111
    v_cvt_pk_bf16_f32 v131, v142, v143
    s_waitcnt lgkmcnt(0)
    ds_read_b64_tr_b16 v[92:93], v13 offset:21504
    ds_read_b64_tr_b16 v[94:95], v13 offset:21760
    ds_read_b64_tr_b16 v[96:97], v13 offset:22528
    ds_read_b64_tr_b16 v[98:99], v13 offset:22784
    ds_read_b64_tr_b16 v[100:101], v13 offset:23552
    ds_read_b64_tr_b16 v[102:103], v13 offset:23808
    ds_read_b128 v[104:107], v14 offset:768
    ds_read_b128 v[108:111], v14 offset:784
    v_mfma_f32_32x32x16_bf16 v[16:31], v[80:83], v[128:131], v[16:31]
    v_lshlrev_b32 v136, 16, v236
    v_and_b32 v137, 0xffff0000, v236
    v_mul_f32 v136, v136, v112
    v_mul_f32 v137, v137, v113
    v_cvt_pk_bf16_f32 v132, v136, v137
    v_lshlrev_b32 v138, 16, v237
    v_and_b32 v139, 0xffff0000, v237
    v_mfma_f32_32x32x16_bf16 v[32:47], v[84:87], v[128:131], v[32:47]
    v_mul_f32 v138, v138, v114
    v_mul_f32 v139, v139, v115
    v_cvt_pk_bf16_f32 v133, v138, v139
    v_lshlrev_b32 v140, 16, v238
    v_and_b32 v141, 0xffff0000, v238
    v_mul_f32 v140, v140, v116
    v_mul_f32 v141, v141, v117
    v_mfma_f32_32x32x16_bf16 v[48:63], v[128:131], v[88:91], v[48:63]
    v_cvt_pk_bf16_f32 v134, v140, v141
    v_lshlrev_b32 v142, 16, v239
    v_and_b32 v143, 0xffff0000, v239
    v_mul_f32 v142, v142, v118
    v_mul_f32 v143, v143, v119
    v_cvt_pk_bf16_f32 v135, v142, v143
    s_waitcnt lgkmcnt(0)
    s_waitcnt vmcnt(0)
    s_barrier
    global_load_dwordx4 v[4:7], v11, s[24:25] sc1
    ds_read_b64_tr_b16 v[80:81], v13 offset:24576
    ds_read_b64_tr_b16 v[82:83], v13 offset:24832
    ds_read_b64_tr_b16 v[84:85], v13 offset:25600
    ds_read_b64_tr_b16 v[86:87], v13 offset:25856
    ds_read_b64_tr_b16 v[88:89], v13 offset:26624
    ds_read_b64_tr_b16 v[90:91], v13 offset:26880
    ds_read_b128 v[112:115], v14 offset:832
    ds_read_b128 v[116:119], v14 offset:848
    v_mfma_f32_32x32x16_bf16 v[16:31], v[92:95], v[132:135], v[16:31]
    v_lshlrev_b32 v136, 16, v240
    v_and_b32 v137, 0xffff0000, v240
    v_mul_f32 v136, v136, v104
    v_mul_f32 v137, v137, v105
    v_cvt_pk_bf16_f32 v128, v136, v137
    v_lshlrev_b32 v138, 16, v241
    v_and_b32 v139, 0xffff0000, v241
    v_mfma_f32_32x32x16_bf16 v[32:47], v[96:99], v[132:135], v[32:47]
    v_mul_f32 v138, v138, v106
    v_mul_f32 v139, v139, v107
    v_cvt_pk_bf16_f32 v129, v138, v139
    v_lshlrev_b32 v140, 16, v242
    v_and_b32 v141, 0xffff0000, v242
    v_mul_f32 v140, v140, v108
    v_mul_f32 v141, v141, v109
    v_mfma_f32_32x32x16_bf16 v[48:63], v[132:135], v[100:103], v[48:63]
    v_cvt_pk_bf16_f32 v130, v140, v141
    v_lshlrev_b32 v142, 16, v243
    v_and_b32 v143, 0xffff0000, v243
    v_mul_f32 v142, v142, v110
    v_mul_f32 v143, v143, v111
    v_cvt_pk_bf16_f32 v131, v142, v143
    s_waitcnt lgkmcnt(0)
    ds_read_b64_tr_b16 v[92:93], v13 offset:27648
    ds_read_b64_tr_b16 v[94:95], v13 offset:27904
    ds_read_b64_tr_b16 v[96:97], v13 offset:28672
    ds_read_b64_tr_b16 v[98:99], v13 offset:28928
    ds_read_b64_tr_b16 v[100:101], v13 offset:29696
    ds_read_b64_tr_b16 v[102:103], v13 offset:29952
    ds_read_b128 v[104:107], v14 offset:896
    ds_read_b128 v[108:111], v14 offset:912
    v_mfma_f32_32x32x16_bf16 v[16:31], v[80:83], v[128:131], v[16:31]
    v_lshlrev_b32 v136, 16, v244
    v_and_b32 v137, 0xffff0000, v244
    v_mul_f32 v136, v136, v112
    v_mul_f32 v137, v137, v113
    v_cvt_pk_bf16_f32 v132, v136, v137
    v_lshlrev_b32 v138, 16, v245
    v_and_b32 v139, 0xffff0000, v245
    v_mfma_f32_32x32x16_bf16 v[32:47], v[84:87], v[128:131], v[32:47]
    v_mul_f32 v138, v138, v114
    v_mul_f32 v139, v139, v115
    v_cvt_pk_bf16_f32 v133, v138, v139
    v_lshlrev_b32 v140, 16, v246
    v_and_b32 v141, 0xffff0000, v246
    v_mul_f32 v140, v140, v116
    v_mul_f32 v141, v141, v117
    v_mfma_f32_32x32x16_bf16 v[48:63], v[128:131], v[88:91], v[48:63]
    v_cvt_pk_bf16_f32 v134, v140, v141
    v_lshlrev_b32 v142, 16, v247
    v_and_b32 v143, 0xffff0000, v247
    v_mul_f32 v142, v142, v118
    v_mul_f32 v143, v143, v119
    v_cvt_pk_bf16_f32 v135, v142, v143
    s_waitcnt lgkmcnt(0)
    ds_read_b64_tr_b16 v[80:81], v13 offset:30720
    ds_read_b64_tr_b16 v[82:83], v13 offset:30976
    ds_read_b64_tr_b16 v[84:85], v13 offset:31744
    ds_read_b64_tr_b16 v[86:87], v13 offset:32000
    ds_read_b64_tr_b16 v[88:89], v13 offset:32768
    ds_read_b64_tr_b16 v[90:91], v13 offset:33024
    ds_read_b128 v[112:115], v14 offset:960
    ds_read_b128 v[116:119], v14 offset:976
    v_mfma_f32_32x32x16_bf16 v[16:31], v[92:95], v[132:135], v[16:31]
    v_lshlrev_b32 v136, 16, v248
    v_and_b32 v137, 0xffff0000, v248
    v_mul_f32 v136, v136, v104
    v_mul_f32 v137, v137, v105
    v_cvt_pk_bf16_f32 v128, v136, v137
    v_lshlrev_b32 v138, 16, v249
    v_and_b32 v139, 0xffff0000, v249
    v_mfma_f32_32x32x16_bf16 v[32:47], v[96:99], v[132:135], v[32:47]
    v_mul_f32 v138, v138, v106
    v_mul_f32 v139, v139, v107
    v_cvt_pk_bf16_f32 v129, v138, v139
    v_lshlrev_b32 v140, 16, v250
    v_and_b32 v141, 0xffff0000, v250
    v_mul_f32 v140, v140, v108
    v_mul_f32 v141, v141, v109
    v_mfma_f32_32x32x16_bf16 v[48:63], v[132:135], v[100:103], v[48:63]
    v_cvt_pk_bf16_f32 v130, v140, v141
    v_lshlrev_b32 v142, 16, v251
    v_and_b32 v143, 0xffff0000, v251
    v_mul_f32 v142, v142, v110
    v_mul_f32 v143, v143, v111
    v_cvt_pk_bf16_f32 v131, v142, v143
    s_waitcnt lgkmcnt(0)
    ds_read_b64_tr_b16 v[92:93], v13 offset:33792
    ds_read_b64_tr_b16 v[94:95], v13 offset:34048
    ds_read_b64_tr_b16 v[96:97], v13 offset:34816
    ds_read_b64_tr_b16 v[98:99], v13 offset:35072
    ds_read_b64_tr_b16 v[100:101], v13 offset:35840
    ds_read_b64_tr_b16 v[102:103], v13 offset:36096
    v_mfma_f32_32x32x16_bf16 v[16:31], v[80:83], v[128:131], v[16:31]
    v_lshlrev_b32 v136, 16, v252
    v_and_b32 v137, 0xffff0000, v252
    v_mul_f32 v136, v136, v112
    v_mul_f32 v137, v137, v113
    v_cvt_pk_bf16_f32 v132, v136, v137
    v_lshlrev_b32 v138, 16, v253
    v_and_b32 v139, 0xffff0000, v253
    v_mfma_f32_32x32x16_bf16 v[32:47], v[84:87], v[128:131], v[32:47]
    v_mul_f32 v138, v138, v114
    v_mul_f32 v139, v139, v115
    v_cvt_pk_bf16_f32 v133, v138, v139
    v_lshlrev_b32 v140, 16, v254
    v_and_b32 v141, 0xffff0000, v254
    v_mul_f32 v140, v140, v116
    v_mul_f32 v141, v141, v117
    v_mfma_f32_32x32x16_bf16 v[48:63], v[128:131], v[88:91], v[48:63]
    v_cvt_pk_bf16_f32 v134, v140, v141
    v_lshlrev_b32 v142, 16, v255
    v_and_b32 v143, 0xffff0000, v255
    v_mul_f32 v142, v142, v118
    v_mul_f32 v143, v143, v119
    v_cvt_pk_bf16_f32 v135, v142, v143
    s_waitcnt lgkmcnt(0)
    v_mfma_f32_32x32x16_bf16 v[16:31], v[92:95], v[132:135], v[16:31]
    v_mfma_f32_32x32x16_bf16 v[32:47], v[96:99], v[132:135], v[32:47]
    v_mfma_f32_32x32x16_bf16 v[48:63], v[132:135], v[100:103], v[48:63]
L_lpend:
    v_lshlrev_b32 v6, 4, v1
    s_mul_i32 s32, s29, 6144
    s_add_u32 s32, s32, 81920
    v_add_u32 v8, s32, v6
    s_xor_b32 s33, s29, 4
    s_mul_i32 s33, s33, 6144
    s_add_u32 s33, s33, 81920
    v_add_u32 v9, s33, v6
    v_and_b32 v12, 15, v1
    v_lshrrev_b32 v13, 1, v12
    v_lshlrev_b32 v13, 7, v13
    v_and_b32 v12, 1, v12
    v_lshlrev_b32 v12, 6, v12
    v_add_u32 v13, v13, v12
    v_lshrrev_b32 v12, 4, v1
    v_lshlrev_b32 v12, 4, v12
    v_add_u32 v13, v13, v12
    s_mul_i32 s32, s31, 768
    s_lshl_b32 s33, s30, 8
    s_add_u32 s32, s32, s33
    s_add_u32 s32, s32, 5120
    v_add_u32 v13, s32, v13
    s_waitcnt vmcnt(0)
    v_cmp_ne_u32 vcc, s26, v7
    s_cbranch_vccz L_st1ok
    s_mov_b32 s64, 200000
L_poll_3:
    global_load_dwordx4 v[4:7], v11, s[24:25] sc1
    s_waitcnt vmcnt(0)
    v_cmp_ne_u32 vcc, s26, v7
    s_cbranch_vccz L_polld_4
    s_sub_u32 s64, s64, 1
    s_cbranch_scc0 L_poll_3
L_polld_4:
L_st1ok:
    v_and_b32 v12, 31, v1
    v_lshlrev_b32 v12, 3, v12
    s_lshl_b32 s32, s30, 8
    s_add_u32 s32, s32, 7168
    v_add_u32 v12, s32, v12
    ds_write_b64 v12, v[4:5]
    s_cmp_lt_u32 s30, 3
    s_cbranch_scc0 L_nout
    s_mov_b32 exec_lo, 0x000f000f
    s_mov_b32 exec_hi, 0x000f000f
    ds_write_b128 v13, v[64:67]
    s_mov_b64 exec, -1
L_nout:
    s_cmp_eq_u32 s31, 0
    s_cbranch_scc0 L_ex1
    ds_write_b128 v8, v[24:27] offset:0
    ds_write_b128 v8, v[28:31] offset:1024
    ds_write_b128 v8, v[40:43] offset:2048
    ds_write_b128 v8, v[44:47] offset:3072
    ds_write_b128 v8, v[56:59] offset:4096
    ds_write_b128 v8, v[60:63] offset:5120
    v_mov_b32 v64, v16
    v_mov_b32 v65, v17
    v_mov_b32 v66, v18
    v_mov_b32 v67, v19
    v_mov_b32 v68, v20
    v_mov_b32 v69, v21
    v_mov_b32 v70, v22
    v_mov_b32 v71, v23
    v_mov_b32 v72, v32
    v_mov_b32 v73, v33
    v_mov_b32 v74, v34
    v_mov_b32 v75, v35
    v_mov_b32 v76, v36
    v_mov_b32 v77, v37
    v_mov_b32 v78, v38
    v_mov_b32 v79, v39
    v_mov_b32 v80, v48
    v_mov_b32 v81, v49
    v_mov_b32 v82, v50
    v_mov_b32 v83, v51
    v_mov_b32 v84, v52
    v_mov_b32 v85, v53
    v_mov_b32 v86, v54
    v_mov_b32 v87, v55
    s_branch L_ex2
L_ex1:
    ds_write_b128 v8, v[16:19] offset:0
    ds_write_b128 v8, v[20:23] offset:1024
    ds_write_b128 v8, v[32:35] offset:2048
    ds_write_b128 v8, v[36:39] offset:3072
    ds_write_b128 v8, v[48:51] offset:4096
    ds_write_b128 v8, v[52:55] offset:5120
    v_mov_b32 v64, v24
    v_mov_b32 v65, v25
    v_mov_b32 v66, v26
    v_mov_b32 v67, v27
    v_mov_b32 v68, v28
    v_mov_b32 v69, v29
    v_mov_b32 v70, v30
    v_mov_b32 v71, v31
    v_mov_b32 v72, v40
    v_mov_b32 v73, v41
    v_mov_b32 v74, v42
    v_mov_b32 v75, v43
    v_mov_b32 v76, v44
    v_mov_b32 v77, v45
    v_mov_b32 v78, v46
    v_mov_b32 v79, v47
    v_mov_b32 v80, v56
    v_mov_b32 v81, v57
    v_mov_b32 v82, v58
    v_mov_b32 v83, v59
    v_mov_b32 v84, v60
    v_mov_b32 v85, v61
    v_mov_b32 v86, v62
    v_mov_b32 v87, v63
L_ex2:
    v_lshrrev_b32 v12, 5, v1
    v_lshlrev_b32 v13, 4, v12
    s_lshl_b32 s32, s31, 6
    s_add_u32 s32, s32, 5120
    v_add_u32 v13, s32, v13
    v_and_b32 v14, 31, v1
    v_lshlrev_b32 v14, 2, v14
    v_lshlrev_b32 v15, 5, v12
    s_lshl_b32 s32, s31, 7
    s_lshl_b32 s33, s30, 8
    s_add_u32 s32, s32, s33
    s_add_u32 s32, s32, 7168
    v_add_u32 v15, s32, v15
    s_waitcnt lgkmcnt(0)
    s_barrier
    ds_read_b128 v[88:91], v9 offset:0
    ds_read_b128 v[92:95], v9 offset:1024
    ds_read_b128 v[96:99], v9 offset:2048
    ds_read_b128 v[100:103], v9 offset:3072
    ds_read_b128 v[104:107], v9 offset:4096
    ds_read_b128 v[108:111], v9 offset:5120
    ds_read_b128 v[16:19], v13 offset:0
    ds_read_b128 v[20:23], v13 offset:32
    ds_read_b128 v[24:27], v13 offset:768
    ds_read_b128 v[28:31], v13 offset:800
    ds_read_b128 v[32:35], v13 offset:128
    ds_read_b128 v[36:39], v13 offset:160
    ds_read_b128 v[40:43], v13 offset:896
    ds_read_b128 v[44:47], v13 offset:928
    s_waitcnt lgkmcnt(8)
    v_add_f32 v64, v64, v88
    v_add_f32 v65, v65, v89
    v_add_f32 v66, v66, v90
    v_add_f32 v67, v67, v91
    v_add_f32 v68, v68, v92
    v_add_f32 v69, v69, v93
    v_add_f32 v70, v70, v94
    v_add_f32 v71, v71, v95
    v_add_f32 v72, v72, v96
    v_add_f32 v73, v73, v97
    v_add_f32 v74, v74, v98
    v_add_f32 v75, v75, v99
    v_add_f32 v76, v76, v100
    v_add_f32 v77, v77, v101
    v_add_f32 v78, v78, v102
    v_add_f32 v79, v79, v103
    v_add_f32 v80, v80, v104
    v_add_f32 v81, v81, v105
    v_add_f32 v82, v82, v106
    v_add_f32 v83, v83, v107
    v_add_f32 v84, v84, v108
    v_add_f32 v85, v85, v109
    v_add_f32 v86, v86, v110
    v_add_f32 v87, v87, v111
    s_waitcnt lgkmcnt(0)
    ds_read_b128 v[112:115], v13 offset:256
    ds_read_b128 v[116:119], v13 offset:288
    ds_read_b128 v[120:123], v13 offset:1024
    ds_read_b128 v[124:127], v13 offset:1056
    ds_read_b128 v[128:131], v13 offset:384
    ds_read_b128 v[132:135], v13 offset:416
    ds_read_b128 v[136:139], v13 offset:1152
    ds_read_b128 v[140:143], v13 offset:1184
    ds_read_b32 v48, v14 offset:5632
    ds_read_b32 v49, v14 offset:6400
    ds_read_b32 v50, v14 offset:5760
    ds_read_b32 v51, v14 offset:6528
    v_add_f32 v16, v16, v24
    v_add_f32 v32, v32, v40
    v_add_f32 v17, v17, v25
    v_add_f32 v33, v33, v41
    v_add_f32 v18, v18, v26
    v_add_f32 v34, v34, v42
    v_add_f32 v19, v19, v27
    v_add_f32 v35, v35, v43
    v_add_f32 v20, v20, v28
    v_add_f32 v36, v36, v44
    v_add_f32 v21, v21, v29
    v_add_f32 v37, v37, v45
    v_add_f32 v22, v22, v30
    v_add_f32 v38, v38, v46
    v_add_f32 v23, v23, v31
    v_add_f32 v39, v39, v47
    v_fma_f32 v16, v16, v4, v32
    v_fma_f32 v17, v17, v4, v33
    v_fma_f32 v18, v18, v4, v34
    v_fma_f32 v19, v19, v4, v35
    v_fma_f32 v20, v20, v4, v36
    v_fma_f32 v21, v21, v4, v37
    v_fma_f32 v22, v22, v4, v38
    v_fma_f32 v23, v23, v4, v39
    v_fma_f32 v64, v64, v5, v16
    v_fma_f32 v65, v65, v5, v17
    v_fma_f32 v66, v66, v5, v18
    v_fma_f32 v67, v67, v5, v19
    v_fma_f32 v68, v68, v5, v20
    v_fma_f32 v69, v69, v5, v21
    v_fma_f32 v70, v70, v5, v22
    v_fma_f32 v71, v71, v5, v23
    s_waitcnt lgkmcnt(0)
    ds_read_b128 v[88:91], v15 offset:0
    ds_read_b128 v[92:95], v15 offset:16
    ds_read_b128 v[96:99], v15 offset:64
    ds_read_b128 v[100:103], v15 offset:80
    v_add_f32 v112, v112, v120
    v_add_f32 v128, v128, v136
    v_add_f32 v113, v113, v121
    v_add_f32 v129, v129, v137
    v_add_f32 v114, v114, v122
    v_add_f32 v130, v130, v138
    v_add_f32 v115, v115, v123
    v_add_f32 v131, v131, v139
    v_add_f32 v116, v116, v124
    v_add_f32 v132, v132, v140
    v_add_f32 v117, v117, v125
    v_add_f32 v133, v133, v141
    v_add_f32 v118, v118, v126
    v_add_f32 v134, v134, v142
    v_add_f32 v119, v119, v127
    v_add_f32 v135, v135, v143
    v_fma_f32 v112, v112, v4, v128
    v_fma_f32 v113, v113, v4, v129
    v_fma_f32 v114, v114, v4, v130
    v_fma_f32 v115, v115, v4, v131
    v_fma_f32 v116, v116, v4, v132
    v_fma_f32 v117, v117, v4, v133
    v_fma_f32 v118, v118, v4, v134
    v_fma_f32 v119, v119, v4, v135
    v_fma_f32 v72, v72, v5, v112
    v_fma_f32 v73, v73, v5, v113
    v_fma_f32 v74, v74, v5, v114
    v_fma_f32 v75, v75, v5, v115
    v_fma_f32 v76, v76, v5, v116
    v_fma_f32 v77, v77, v5, v117
    v_fma_f32 v78, v78, v5, v118
    v_fma_f32 v79, v79, v5, v119
    v_add_f32 v48, v48, v49
    v_add_f32 v50, v50, v51
    s_waitcnt lgkmcnt(0)
    v_fma_f32 v88, v88, v48, v50
    v_fma_f32 v90, v90, v48, v50
    v_fma_f32 v92, v92, v48, v50
    v_fma_f32 v94, v94, v48, v50
    v_fma_f32 v96, v96, v48, v50
    v_fma_f32 v98, v98, v48, v50
    v_fma_f32 v100, v100, v48, v50
    v_fma_f32 v102, v102, v48, v50
    v_fma_f32 v80, v80, v89, v88
    v_fma_f32 v81, v81, v91, v90
    v_fma_f32 v82, v82, v93, v92
    v_fma_f32 v83, v83, v95, v94
    v_fma_f32 v84, v84, v97, v96
    v_fma_f32 v85, v85, v99, v98
    v_fma_f32 v86, v86, v101, v100
    v_fma_f32 v87, v87, v103, v102
    v_lshlrev_b32 v6, 4, v1
    s_mov_b32 s32, 0x3eb8aa3b
    v_mul_f32 v64, s32, v64
    v_mul_f32 v65, s32, v65
    v_mul_f32 v66, s32, v66
    v_mul_f32 v67, s32, v67
    v_mul_f32 v68, s32, v68
    v_mul_f32 v69, s32, v69
    v_mul_f32 v70, s32, v70
    v_mul_f32 v71, s32, v71
    v_cvt_pk_bf16_f32 v2, v64, v65
    v_cvt_pk_bf16_f32 v8, v72, v73
    v_cvt_pk_bf16_f32 v12, v80, v81
    v_cvt_pk_bf16_f32 v3, v66, v67
    v_cvt_pk_bf16_f32 v9, v74, v75
    v_cvt_pk_bf16_f32 v13, v82, v83
    v_cvt_pk_bf16_f32 v4, v68, v69
    v_cvt_pk_bf16_f32 v10, v76, v77
    v_cvt_pk_bf16_f32 v14, v84, v85
    v_cvt_pk_bf16_f32 v5, v70, v71
    v_cvt_pk_bf16_f32 v11, v78, v79
    v_cvt_pk_bf16_f32 v15, v86, v87
    s_lshl_b32 s32, s31, 10
    v_add_u32 v16, s32, v6
    v_bfe_u32 v17, v1, 4, 1
    v_lshlrev_b32 v17, 10, v17
    v_lshrrev_b32 v18, 5, v1
    v_lshlrev_b32 v18, 8, v18
    v_add_u32 v17, v17, v18
    v_and_b32 v18, 15, v1
    v_lshlrev_b32 v18, 4, v18
    v_add_u32 v17, v17, v18
    s_lshl_b32 s32, s31, 9
    s_add_u32 s32, s32, 2048
    v_add_u32 v17, s32, v17
    s_lshl_b32 s32, s27, 2
    s_add_u32 s32, s32, s30
    s_lshl_b32 s32, s32, 4
    s_add_u32 s32, s32, s28
    s_lshl_b32 s32, s32, 12
    s_add_u32 s32, s32, 1048576
    v_add_u32 v18, s32, v16
    v_add_u32 v19, s32, v17
    global_store_dwordx4 v18, v[8:11], s[24:25] sc1
    global_store_dwordx4 v19, v[12:15], s[24:25] sc1
    s_add_u32 s32, s30, 8
    s_lshl_b32 s32, s32, 11
    s_add_u32 s33, s32, 32768
    s_add_u32 s32, s32, 6144
    v_add_u32 v16, s33, v16
    v_add_u32 v17, s32, v17
    ds_write_b128 v16, v[8:11]
    ds_write_b128 v17, v[12:15]
    s_and_b32 s32, s2, 7
    s_lshr_b32 s33, s2, 3
    s_mul_i32 s56, s32, 11
    s_add_u32 s56, s56, s33
    s_cmp_lt_u32 s56, 86
    s_cselect_b32 s57, 1, 0
    s_cmp_lt_u32 s2, 88
    s_cselect_b32 s57, s57, 0
    s_cmp_ge_u32 s2, 224
    s_cbranch_scc0 L_rolex
    s_mov_b32 s57, 2
    s_lshl_b32 s56, s32, 2
    s_add_u32 s56, s56, s33
    s_sub_u32 s56, s56, 28
L_rolex:
    s_and_b32 s40, s28, 3
    s_lshr_b32 s41, s28, 2
    s_lshl_b32 s32, s27, 2
    s_add_u32 s41, s41, s32
    s_add_u32 s43, s32, s30
    s_sub_u32 s42, 8, s43
    s_max_i32 s42, s42, 0
    s_lshl_b32 s32, s27, 4
    s_add_u32 s32, s32, s28
    s_lshl_b32 s32, s32, 3
    s_add_u32 s32, s32, s29
    s_lshl_b32 s32, s32, 3
    s_add_u32 s32, s32, 32768
    v_mov_b32 v6, s32
    v_mov_b32 v8, s26
    v_mov_b32 v9, s26
    v_lshrrev_b32 v10, 4, v1
    v_lshlrev_b32 v7, 2, v10
    v_and_b32 v11, 15, v1
    v_xor_b32 v7, v7, v11
    v_lshlrev_b32 v7, 4, v7
    v_lshlrev_b32 v10, 10, v10
    v_add_u32 v184, v10, v7
    v_and_b32 v10, 31, v1
    s_lshl_b32 s32, s41, 5
    v_add_u32 v10, s32, v10
    v_lshlrev_b32 v10, 10, v10
    v_lshrrev_b32 v7, 5, v1
    v_lshlrev_b32 v7, 5, v7
    v_add_u32 v10, v10, v7
    s_lshl_b32 s32, s40, 8
    s_lshl_b32 s33, s30, 6
    s_add_u32 s32, s32, s33
    s_lshl_b32 s33, s31, 4
    s_add_u32 s32, s32, s33
    v_add_u32 v185, s32, v10
    s_waitcnt vmcnt(0)
    s_mov_b64 exec, 1
    global_store_dwordx2 v6, v[8:9], s[24:25] sc1
    s_mov_b64 exec, -1
    s_waitcnt lgkmcnt(0)
    s_barrier
    s_cmp_eq_u32 s29, 7
    s_cbranch_scc0 L_nom2a
    v_lshlrev_b32 v157, 4, v1
    s_and_b32 s36, s2, 7
    s_lshl_b32 s36, s36, 8
    s_lshr_b32 s37, s2, 3
    s_lshl_b32 s37, s37, 3
    s_add_u32 s46, s36, s37
    s_lshl_b32 s36, s46, 1
    s_add_u32 s36, s36, 2048
    global_load_dwordx4 v[148:151], v157, s[18:19]
    s_movk_i32 s32, 6144
    v_mul_lo_u32 v153, v1, s32
    s_add_u32 s34, s20, s36
    s_addc_u32 s35, s21, 0
    s_mov_b32 m0, 139264
    s_nop 0
    global_load_lds_dwordx4 v153, s[34:35]
    s_add_u32 s34, s34, 393216
    s_addc_u32 s35, s35, 0
    s_add_u32 m0, m0, 1024
    s_nop 0
    global_load_lds_dwordx4 v153, s[34:35]
    s_add_u32 s34, s34, 393216
    s_addc_u32 s35, s35, 0
    s_add_u32 m0, m0, 1024
    s_nop 0
    global_load_lds_dwordx4 v153, s[34:35]
    s_add_u32 s34, s34, 393216
    s_addc_u32 s35, s35, 0
    s_add_u32 m0, m0, 1024
    s_nop 0
    global_load_lds_dwordx4 v153, s[34:35]
    s_add_u32 s34, s34, 393216
    s_addc_u32 s35, s35, 0
    s_add_u32 m0, m0, 1024
    s_nop 0
    global_load_lds_dwordx4 v153, s[34:35]
    s_add_u32 s34, s34, 393216
    s_addc_u32 s35, s35, 0
    s_add_u32 m0, m0, 1024
    s_nop 0
    global_load_lds_dwordx4 v153, s[34:35]
    s_add_u32 s34, s34, 393216
    s_addc_u32 s35, s35, 0
    s_add_u32 m0, m0, 1024
    s_nop 0
    global_load_lds_dwordx4 v153, s[34:35]
    s_add_u32 s34, s34, 393216
    s_addc_u32 s35, s35, 0
    s_add_u32 m0, m0, 1024
    s_nop 0
    global_load_lds_dwordx4 v153, s[34:35]
L_nom2a:
    global_load_dwordx4 v[180:183], v185, s[4:5]
    s_lshl_b32 s32, s27, 2
    s_add_u32 s32, s32, s29
    s_cmp_lt_u32 s32, 8
    s_cbranch_scc1 L_norem
    s_sub_u32 s36, s32, 8
    s_lshr_b32 s33, s36, 2
    s_lshl_b32 s33, s33, 4
    s_add_u32 s33, s33, s28
    s_lshl_b32 s33, s33, 3
    s_add_u32 s33, s33, s30
    s_lshl_b32 s33, s33, 3
    s_add_u32 s33, s33, 32768
    v_and_b32 v6, 1, v1
    v_lshlrev_b32 v6, 5, v6
    v_add_u32 v6, s33, v6
    s_cmp_eq_u32 s29, 7
    s_cbranch_scc0 L_nom2b
    s_waitcnt vmcnt(9)
    v_lshlrev_b32 v16, 16, v148
    v_and_b32 v17, 0xffff0000, v148
    v_lshlrev_b32 v18, 16, v149
    v_and_b32 v19, 0xffff0000, v149
    v_lshlrev_b32 v20, 16, v150
    v_and_b32 v21, 0xffff0000, v150
    v_lshlrev_b32 v22, 16, v151
    v_and_b32 v23, 0xffff0000, v151
    v_mul_f32 v24, 0xbfb8aa3b, v16
    v_mul_f32 v25, 0xbfb8aa3b, v17
    v_mul_f32 v26, 0xbfb8aa3b, v18
    v_mul_f32 v27, 0xbfb8aa3b, v19
    v_mul_f32 v28, 0xbfb8aa3b, v20
    v_mul_f32 v29, 0xbfb8aa3b, v21
    v_mul_f32 v30, 0xbfb8aa3b, v22
    v_mul_f32 v31, 0xbfb8aa3b, v23
    v_exp_f32 v24, v24
    v_exp_f32 v25, v25
    v_exp_f32 v26, v26
    v_exp_f32 v27, v27
    v_exp_f32 v28, v28
    v_exp_f32 v29, v29
    v_exp_f32 v30, v30
    v_exp_f32 v31, v31
    v_add_f32 v24, 1.0, v24
    v_add_f32 v25, 1.0, v25
    v_add_f32 v26, 1.0, v26
    v_add_f32 v27, 1.0, v27
    v_add_f32 v28, 1.0, v28
    v_add_f32 v29, 1.0, v29
    v_add_f32 v30, 1.0, v30
    v_add_f32 v31, 1.0, v31
    v_rcp_f32 v24, v24
    v_rcp_f32 v25, v25
    v_rcp_f32 v26, v26
    v_rcp_f32 v27, v27
    v_rcp_f32 v28, v28
    v_rcp_f32 v29, v29
    v_rcp_f32 v30, v30
    v_rcp_f32 v31, v31
    v_mul_f32 v16, v16, v24
    v_mul_f32 v17, v17, v25
    v_mul_f32 v18, v18, v26
    v_mul_f32 v19, v19, v27
    v_mul_f32 v20, v20, v28
    v_mul_f32 v21, v21, v29
    v_mul_f32 v22, v22, v30
    v_mul_f32 v23, v23, v31
    v_cvt_pk_bf16_f32 v148, v16, v17
    v_cvt_pk_bf16_f32 v149, v18, v19
    v_cvt_pk_bf16_f32 v150, v20, v21
    v_cvt_pk_bf16_f32 v151, v22, v23
    v_add_u32 v154, 147456, v157
    ds_write_b128 v154, v[148:151]
    v_lshrrev_b32 v154, 4, v1
    v_lshlrev_b32 v155, 4, v154
    v_add_u32 v155, 147456, v155
    v_lshlrev_b32 v154, 7, v154
    v_bfe_u32 v156, v1, 2, 2
    v_lshlrev_b32 v156, 4, v156
    v_add_u32 v154, v154, v156
    v_and_b32 v156, 1, v1
    v_lshlrev_b32 v156, 3, v156
    v_add_u32 v154, v154, v156
    v_add_u32 v154, 139264, v154
    v_mov_b32 v144, 0
    v_mov_b32 v145, 0
    v_mov_b32 v146, 0
    v_mov_b32 v147, 0
    s_waitcnt lgkmcnt(0)
    ds_read_b128 v[16:19], v155 offset:0
    ds_read_b128 v[20:23], v155 offset:64
    ds_read_b128 v[24:27], v155 offset:128
    ds_read_b128 v[28:31], v155 offset:192
    ds_read_b128 v[32:35], v155 offset:256
    ds_read_b128 v[36:39], v155 offset:320
    ds_read_b128 v[40:43], v155 offset:384
    ds_read_b128 v[44:47], v155 offset:448
    ds_read_b128 v[48:51], v155 offset:512
    ds_read_b128 v[52:55], v155 offset:576
    ds_read_b128 v[56:59], v155 offset:640
    ds_read_b128 v[60:63], v155 offset:704
    s_waitcnt lgkmcnt(4)
    ds_read_b128 v[64:67], v155 offset:768
    ds_read_b128 v[68:71], v155 offset:832
    ds_read_b128 v[72:75], v155 offset:896
    ds_read_b128 v[76:79], v155 offset:960
    s_waitcnt vmcnt(1) lgkmcnt(0)
    ds_read_b64_tr_b16 v[80:81], v154 offset:0
    ds_read_b64_tr_b16 v[82:83], v154 offset:64
    ds_read_b64_tr_b16 v[84:85], v154 offset:512
    ds_read_b64_tr_b16 v[86:87], v154 offset:576
    ds_read_b64_tr_b16 v[88:89], v154 offset:1024
    ds_read_b64_tr_b16 v[90:91], v154 offset:1088
    ds_read_b64_tr_b16 v[92:93], v154 offset:1536
    ds_read_b64_tr_b16 v[94:95], v154 offset:1600
    ds_read_b64_tr_b16 v[96:97], v154 offset:2048
    ds_read_b64_tr_b16 v[98:99], v154 offset:2112
    ds_read_b64_tr_b16 v[100:101], v154 offset:2560
    ds_read_b64_tr_b16 v[102:103], v154 offset:2624
    ds_read_b64_tr_b16 v[104:105], v154 offset:3072
    ds_read_b64_tr_b16 v[106:107], v154 offset:3136
    ds_read_b64_tr_b16 v[108:109], v154 offset:3584
    ds_read_b64_tr_b16 v[110:111], v154 offset:3648
    s_waitcnt lgkmcnt(8)
    v_mfma_f32_16x16x32_bf16 v[144:147], v[16:19], v[80:83], v[144:147]
    v_mfma_f32_16x16x32_bf16 v[144:147], v[20:23], v[84:87], v[144:147]
    v_mfma_f32_16x16x32_bf16 v[144:147], v[24:27], v[88:91], v[144:147]
    v_mfma_f32_16x16x32_bf16 v[144:147], v[28:31], v[92:95], v[144:147]
    ds_read_b64_tr_b16 v[112:113], v154 offset:4096
    ds_read_b64_tr_b16 v[114:115], v154 offset:4160
    ds_read_b64_tr_b16 v[116:117], v154 offset:4608
    ds_read_b64_tr_b16 v[118:119], v154 offset:4672
    ds_read_b64_tr_b16 v[120:121], v154 offset:5120
    ds_read_b64_tr_b16 v[122:123], v154 offset:5184
    ds_read_b64_tr_b16 v[124:125], v154 offset:5632
    ds_read_b64_tr_b16 v[126:127], v154 offset:5696
    s_waitcnt lgkmcnt(8)
    v_mfma_f32_16x16x32_bf16 v[144:147], v[32:35], v[96:99], v[144:147]
    v_mfma_f32_16x16x32_bf16 v[144:147], v[36:39], v[100:103], v[144:147]
    v_mfma_f32_16x16x32_bf16 v[144:147], v[40:43], v[104:107], v[144:147]
    v_mfma_f32_16x16x32_bf16 v[144:147], v[44:47], v[108:111], v[144:147]
    ds_read_b64_tr_b16 v[128:129], v154 offset:6144
    ds_read_b64_tr_b16 v[130:131], v154 offset:6208
    ds_read_b64_tr_b16 v[132:133], v154 offset:6656
    ds_read_b64_tr_b16 v[134:135], v154 offset:6720
    ds_read_b64_tr_b16 v[136:137], v154 offset:7168
    ds_read_b64_tr_b16 v[138:139], v154 offset:7232
    ds_read_b64_tr_b16 v[140:141], v154 offset:7680
    ds_read_b64_tr_b16 v[142:143], v154 offset:7744
    s_waitcnt lgkmcnt(8)
    v_mfma_f32_16x16x32_bf16 v[144:147], v[48:51], v[112:115], v[144:147]
    v_mfma_f32_16x16x32_bf16 v[144:147], v[52:55], v[116:119], v[144:147]
    v_mfma_f32_16x16x32_bf16 v[144:147], v[56:59], v[120:123], v[144:147]
    v_mfma_f32_16x16x32_bf16 v[144:147], v[60:63], v[124:127], v[144:147]
    s_waitcnt lgkmcnt(0)
    v_mfma_f32_16x16x32_bf16 v[144:147], v[64:67], v[128:131], v[144:147]
    v_mfma_f32_16x16x32_bf16 v[144:147], v[68:71], v[132:135], v[144:147]
    v_mfma_f32_16x16x32_bf16 v[144:147], v[72:75], v[136:139], v[144:147]
    v_mfma_f32_16x16x32_bf16 v[144:147], v[76:79], v[140:143], v[144:147]
    s_nop 7
    s_nop 1
    v_mov_b32 v152, v144
    v_cvt_pk_bf16_f32 v152, v152, v152
    v_and_b32 v152, 0xffff0000, v152
    v_mov_b32 v153, s26
    v_add_u32 v154, s46, v1
    v_lshlrev_b32 v154, 3, v154
    v_add_u32 v154, 8192, v154
    s_mov_b64 exec, 0xff
    global_store_dwordx2 v154, v[152:153], s[24:25] sc1
    s_mov_b64 exec, -1
L_nom2b:
    s_mov_b32 s64, 200000
L_poll_5:
    global_load_dwordx2 v[8:9], v6, s[24:25] sc1
    s_waitcnt vmcnt(0)
    v_cmp_ne_u32 vcc, s26, v9
    s_cbranch_vccz L_polld_6
    s_sub_u32 s64, s64, 1
    s_cbranch_scc0 L_poll_5
L_polld_6:
    s_lshl_b32 s36, s36, 4
    s_add_u32 s36, s36, s28
    s_lshl_b32 s36, s36, 12
    s_add_u32 s36, s36, 1048576
    v_lshlrev_b32 v6, 4, v1
    v_add_u32 v6, s36, v6
    s_lshl_b32 s32, s29, 11
    s_add_u32 m0, s32, 32768
    s_nop 0
    global_load_lds_dwordx4 v6, s[24:25] offset:0 sc1
    global_load_lds_dwordx4 v6, s[24:25] offset:1024 sc1
    s_add_u32 m0, s32, 6144
    s_nop 0
    global_load_lds_dwordx4 v6, s[24:25] offset:2048 sc1
    global_load_lds_dwordx4 v6, s[24:25] offset:3072 sc1
    s_branch L_remd
L_norem:
    s_cmp_eq_u32 s29, 7
    s_cbranch_scc0 L_remd
    s_waitcnt vmcnt(9)
    v_lshlrev_b32 v16, 16, v148
    v_and_b32 v17, 0xffff0000, v148
    v_lshlrev_b32 v18, 16, v149
    v_and_b32 v19, 0xffff0000, v149
    v_lshlrev_b32 v20, 16, v150
    v_and_b32 v21, 0xffff0000, v150
    v_lshlrev_b32 v22, 16, v151
    v_and_b32 v23, 0xffff0000, v151
    v_mul_f32 v24, 0xbfb8aa3b, v16
    v_mul_f32 v25, 0xbfb8aa3b, v17
    v_mul_f32 v26, 0xbfb8aa3b, v18
    v_mul_f32 v27, 0xbfb8aa3b, v19
    v_mul_f32 v28, 0xbfb8aa3b, v20
    v_mul_f32 v29, 0xbfb8aa3b, v21
    v_mul_f32 v30, 0xbfb8aa3b, v22
    v_mul_f32 v31, 0xbfb8aa3b, v23
    v_exp_f32 v24, v24
    v_exp_f32 v25, v25
    v_exp_f32 v26, v26
    v_exp_f32 v27, v27
    v_exp_f32 v28, v28
    v_exp_f32 v29, v29
    v_exp_f32 v30, v30
    v_exp_f32 v31, v31
    v_add_f32 v24, 1.0, v24
    v_add_f32 v25, 1.0, v25
    v_add_f32 v26, 1.0, v26
    v_add_f32 v27, 1.0, v27
    v_add_f32 v28, 1.0, v28
    v_add_f32 v29, 1.0, v29
    v_add_f32 v30, 1.0, v30
    v_add_f32 v31, 1.0, v31
    v_rcp_f32 v24, v24
    v_rcp_f32 v25, v25
    v_rcp_f32 v26, v26
    v_rcp_f32 v27, v27
    v_rcp_f32 v28, v28
    v_rcp_f32 v29, v29
    v_rcp_f32 v30, v30
    v_rcp_f32 v31, v31
    v_mul_f32 v16, v16, v24
    v_mul_f32 v17, v17, v25
    v_mul_f32 v18, v18, v26
    v_mul_f32 v19, v19, v27
    v_mul_f32 v20, v20, v28
    v_mul_f32 v21, v21, v29
    v_mul_f32 v22, v22, v30
    v_mul_f32 v23, v23, v31
    v_cvt_pk_bf16_f32 v148, v16, v17
    v_cvt_pk_bf16_f32 v149, v18, v19
    v_cvt_pk_bf16_f32 v150, v20, v21
    v_cvt_pk_bf16_f32 v151, v22, v23
    v_add_u32 v154, 147456, v157
    ds_write_b128 v154, v[148:151]
    v_lshrrev_b32 v154, 4, v1
    v_lshlrev_b32 v155, 4, v154
    v_add_u32 v155, 147456, v155
    v_lshlrev_b32 v154, 7, v154
    v_bfe_u32 v156, v1, 2, 2
    v_lshlrev_b32 v156, 4, v156
    v_add_u32 v154, v154, v156
    v_and_b32 v156, 1, v1
    v_lshlrev_b32 v156, 3, v156
    v_add_u32 v154, v154, v156
    v_add_u32 v154, 139264, v154
    v_mov_b32 v144, 0
    v_mov_b32 v145, 0
    v_mov_b32 v146, 0
    v_mov_b32 v147, 0
    s_waitcnt lgkmcnt(0)
    ds_read_b128 v[16:19], v155 offset:0
    ds_read_b128 v[20:23], v155 offset:64
    ds_read_b128 v[24:27], v155 offset:128
    ds_read_b128 v[28:31], v155 offset:192
    ds_read_b128 v[32:35], v155 offset:256
    ds_read_b128 v[36:39], v155 offset:320
    ds_read_b128 v[40:43], v155 offset:384
    ds_read_b128 v[44:47], v155 offset:448
    ds_read_b128 v[48:51], v155 offset:512
    ds_read_b128 v[52:55], v155 offset:576
    ds_read_b128 v[56:59], v155 offset:640
    ds_read_b128 v[60:63], v155 offset:704
    s_waitcnt lgkmcnt(4)
    ds_read_b128 v[64:67], v155 offset:768
    ds_read_b128 v[68:71], v155 offset:832
    ds_read_b128 v[72:75], v155 offset:896
    ds_read_b128 v[76:79], v155 offset:960
    s_waitcnt vmcnt(1) lgkmcnt(0)
    ds_read_b64_tr_b16 v[80:81], v154 offset:0
    ds_read_b64_tr_b16 v[82:83], v154 offset:64
    ds_read_b64_tr_b16 v[84:85], v154 offset:512
    ds_read_b64_tr_b16 v[86:87], v154 offset:576
    ds_read_b64_tr_b16 v[88:89], v154 offset:1024
    ds_read_b64_tr_b16 v[90:91], v154 offset:1088
    ds_read_b64_tr_b16 v[92:93], v154 offset:1536
    ds_read_b64_tr_b16 v[94:95], v154 offset:1600
    ds_read_b64_tr_b16 v[96:97], v154 offset:2048
    ds_read_b64_tr_b16 v[98:99], v154 offset:2112
    ds_read_b64_tr_b16 v[100:101], v154 offset:2560
    ds_read_b64_tr_b16 v[102:103], v154 offset:2624
    ds_read_b64_tr_b16 v[104:105], v154 offset:3072
    ds_read_b64_tr_b16 v[106:107], v154 offset:3136
    ds_read_b64_tr_b16 v[108:109], v154 offset:3584
    ds_read_b64_tr_b16 v[110:111], v154 offset:3648
    s_waitcnt lgkmcnt(8)
    v_mfma_f32_16x16x32_bf16 v[144:147], v[16:19], v[80:83], v[144:147]
    v_mfma_f32_16x16x32_bf16 v[144:147], v[20:23], v[84:87], v[144:147]
    v_mfma_f32_16x16x32_bf16 v[144:147], v[24:27], v[88:91], v[144:147]
    v_mfma_f32_16x16x32_bf16 v[144:147], v[28:31], v[92:95], v[144:147]
    ds_read_b64_tr_b16 v[112:113], v154 offset:4096
    ds_read_b64_tr_b16 v[114:115], v154 offset:4160
    ds_read_b64_tr_b16 v[116:117], v154 offset:4608
    ds_read_b64_tr_b16 v[118:119], v154 offset:4672
    ds_read_b64_tr_b16 v[120:121], v154 offset:5120
    ds_read_b64_tr_b16 v[122:123], v154 offset:5184
    ds_read_b64_tr_b16 v[124:125], v154 offset:5632
    ds_read_b64_tr_b16 v[126:127], v154 offset:5696
    s_waitcnt lgkmcnt(8)
    v_mfma_f32_16x16x32_bf16 v[144:147], v[32:35], v[96:99], v[144:147]
    v_mfma_f32_16x16x32_bf16 v[144:147], v[36:39], v[100:103], v[144:147]
    v_mfma_f32_16x16x32_bf16 v[144:147], v[40:43], v[104:107], v[144:147]
    v_mfma_f32_16x16x32_bf16 v[144:147], v[44:47], v[108:111], v[144:147]
    ds_read_b64_tr_b16 v[128:129], v154 offset:6144
    ds_read_b64_tr_b16 v[130:131], v154 offset:6208
    ds_read_b64_tr_b16 v[132:133], v154 offset:6656
    ds_read_b64_tr_b16 v[134:135], v154 offset:6720
    ds_read_b64_tr_b16 v[136:137], v154 offset:7168
    ds_read_b64_tr_b16 v[138:139], v154 offset:7232
    ds_read_b64_tr_b16 v[140:141], v154 offset:7680
    ds_read_b64_tr_b16 v[142:143], v154 offset:7744
    s_waitcnt lgkmcnt(8)
    v_mfma_f32_16x16x32_bf16 v[144:147], v[48:51], v[112:115], v[144:147]
    v_mfma_f32_16x16x32_bf16 v[144:147], v[52:55], v[116:119], v[144:147]
    v_mfma_f32_16x16x32_bf16 v[144:147], v[56:59], v[120:123], v[144:147]
    v_mfma_f32_16x16x32_bf16 v[144:147], v[60:63], v[124:127], v[144:147]
    s_waitcnt lgkmcnt(0)
    v_mfma_f32_16x16x32_bf16 v[144:147], v[64:67], v[128:131], v[144:147]
    v_mfma_f32_16x16x32_bf16 v[144:147], v[68:71], v[132:135], v[144:147]
    v_mfma_f32_16x16x32_bf16 v[144:147], v[72:75], v[136:139], v[144:147]
    v_mfma_f32_16x16x32_bf16 v[144:147], v[76:79], v[140:143], v[144:147]
    s_nop 7
    s_nop 1
    v_mov_b32 v152, v144
    v_cvt_pk_bf16_f32 v152, v152, v152
    v_and_b32 v152, 0xffff0000, v152
    v_mov_b32 v153, s26
    v_add_u32 v154, s46, v1
    v_lshlrev_b32 v154, 3, v154
    v_add_u32 v154, 8192, v154
    s_mov_b64 exec, 0xff
    global_store_dwordx2 v154, v[152:153], s[24:25] sc1
    s_mov_b64 exec, -1
L_remd:
    v_and_b32 v6, 31, v1
    v_lshrrev_b32 v7, 5, v1
    v_lshlrev_b32 v7, 2, v7
    v_sub_u32 v6, v6, v7
    v_mov_b32 v7, 0xf149f2ca
    v_cmp_le_i32 vcc, 0, v6
    v_cndmask_b32_e64 v148, v7, 0, vcc
    v_cndmask_b32_e64 v132, 0, v7, vcc
    v_cmp_le_i32 vcc, 1, v6
    v_cndmask_b32_e64 v149, v7, 0, vcc
    v_cndmask_b32_e64 v133, 0, v7, vcc
    v_cmp_le_i32 vcc, 2, v6
    v_cndmask_b32_e64 v150, v7, 0, vcc
    v_cndmask_b32_e64 v134, 0, v7, vcc
    v_cmp_le_i32 vcc, 3, v6
    v_cndmask_b32_e64 v151, v7, 0, vcc
    v_cndmask_b32_e64 v135, 0, v7, vcc
    v_cmp_le_i32 vcc, 8, v6
    v_cndmask_b32_e64 v152, v7, 0, vcc
    v_cndmask_b32_e64 v136, 0, v7, vcc
    v_cmp_le_i32 vcc, 9, v6
    v_cndmask_b32_e64 v153, v7, 0, vcc
    v_cndmask_b32_e64 v137, 0, v7, vcc
    v_cmp_le_i32 vcc, 10, v6
    v_cndmask_b32_e64 v154, v7, 0, vcc
    v_cndmask_b32_e64 v138, 0, v7, vcc
    v_cmp_le_i32 vcc, 11, v6
    v_cndmask_b32_e64 v155, v7, 0, vcc
    v_cndmask_b32_e64 v139, 0, v7, vcc
    v_cmp_le_i32 vcc, 16, v6
    v_cndmask_b32_e64 v156, v7, 0, vcc
    v_cndmask_b32_e64 v140, 0, v7, vcc
    v_cmp_le_i32 vcc, 17, v6
    v_cndmask_b32_e64 v157, v7, 0, vcc
    v_cndmask_b32_e64 v141, 0, v7, vcc
    v_cmp_le_i32 vcc, 18, v6
    v_cndmask_b32_e64 v158, v7, 0, vcc
    v_cndmask_b32_e64 v142, 0, v7, vcc
    v_cmp_le_i32 vcc, 19, v6
    v_cndmask_b32_e64 v159, v7, 0, vcc
    v_cndmask_b32_e64 v143, 0, v7, vcc
    v_cmp_le_i32 vcc, 24, v6
    v_cndmask_b32_e64 v160, v7, 0, vcc
    v_cndmask_b32_e64 v144, 0, v7, vcc
    v_cmp_le_i32 vcc, 25, v6
    v_cndmask_b32_e64 v161, v7, 0, vcc
    v_cndmask_b32_e64 v145, 0, v7, vcc
    v_cmp_le_i32 vcc, 26, v6
    v_cndmask_b32_e64 v162, v7, 0, vcc
    v_cndmask_b32_e64 v146, 0, v7, vcc
    v_cmp_le_i32 vcc, 27, v6
    v_cndmask_b32_e64 v163, v7, 0, vcc
    v_cndmask_b32_e64 v147, 0, v7, vcc
    s_lshl_b32 s32, s30, 11
    s_lshl_b32 s33, s31, 10
    s_add_u32 s32, s32, s33
    s_add_u32 s33, s32, 32768
    v_lshlrev_b32 v6, 4, v1
    v_add_u32 v186, s33, v6
    v_lshrrev_b32 v6, 5, v1
    v_lshlrev_b32 v6, 8, v6
    v_and_b32 v7, 15, v1
    v_lshlrev_b32 v7, 4, v7
    v_add_u32 v6, v6, v7
    s_add_u32 s32, s32, 8192
    v_add_u32 v187, s32, v6
    v_mov_b32 v52, 0x3f803f80
    v_mov_b32 v53, 0x3f803f80
    v_mov_b32 v54, 0x3f803f80
    v_mov_b32 v55, 0x3f803f80
    v_mov_b32 v56, 0x3f803f80
    v_mov_b32 v57, 0x3f803f80
    v_mov_b32 v58, 0x3f803f80
    v_mov_b32 v59, 0x3f803f80
    v_mov_b32 v60, 0x3f803f80
    v_mov_b32 v61, 0x3f803f80
    v_mov_b32 v62, 0x3f803f80
    v_mov_b32 v63, 0x3f803f80
    v_mov_b32 v64, 0x3f803f80
    v_mov_b32 v65, 0x3f803f80
    v_mov_b32 v66, 0x3f803f80
    v_mov_b32 v67, 0x3f803f80
    v_mov_b32 v164, 0
    v_mov_b32 v165, 0
    v_mov_b32 v166, 0
    v_mov_b32 v167, 0
    v_mov_b32 v168, 0
    v_mov_b32 v169, 0
    v_mov_b32 v170, 0
    v_mov_b32 v171, 0
    v_mov_b32 v172, 0
    v_mov_b32 v173, 0
    v_mov_b32 v174, 0
    v_mov_b32 v175, 0
    v_mov_b32 v176, 0
    v_mov_b32 v177, 0
    v_mov_b32 v178, 0
    v_mov_b32 v179, 0
    v_lshrrev_b32 v6, 5, v1
    v_lshlrev_b32 v6, 10, v6
    v_bfe_u32 v7, v1, 2, 2
    v_lshlrev_b32 v8, 8, v7
    v_add_u32 v6, v6, v8
    v_xor_b32 v7, s30, v7
    v_lshlrev_b32 v7, 6, v7
    v_add_u32 v6, v6, v7
    v_and_b32 v7, 1, v1
    v_lshlrev_b32 v7, 5, v7
    v_add_u32 v6, v6, v7
    v_bfe_u32 v7, v1, 4, 1
    v_lshlrev_b32 v7, 4, v7
    v_add_u32 v6, v6, v7
    v_bfe_u32 v7, v1, 1, 1
    v_lshlrev_b32 v7, 3, v7
    v_add_u32 v6, v6, v7
    s_lshl_b32 s32, s31, 12
    s_add_u32 s32, s32, 57344
    v_add_u32 v188, s32, v6
    s_lshl_b32 s32, s29, 12
    s_lshl_b32 s33, s40, 8
    s_add_u32 s32, s32, s33
    s_add_u32 s52, s8, s32
    s_addc_u32 s53, s9, 0
    s_lshl_b32 s54, s29, 10
    s_add_u32 s54, s54, 57344
    s_waitcnt vmcnt(0) lgkmcnt(0)
    s_barrier
    ds_read_b128 v[16:19], v186 offset:0
    ds_read_b128 v[20:23], v186 offset:2048
    ds_read_b128 v[24:27], v186 offset:4096
    ds_read_b128 v[28:31], v186 offset:6144
    ds_read_b128 v[32:35], v186 offset:8192
    ds_read_b128 v[36:39], v186 offset:10240
    ds_read_b128 v[40:43], v186 offset:12288
    ds_read_b128 v[44:47], v186 offset:14336
    ds_read_b128 v[48:51], v186 offset:16384
    s_cmp_lt_u32 s29, 3
    s_cbranch_scc0 L_l2x
    s_and_b32 s32, s2, 7
    s_lshr_b32 s33, s2, 3
    s_cmp_eq_u32 s29, 2
    s_cbranch_scc1 L_l2d
    v_lshrrev_b32 v8, 2, v1
    s_lshl_b32 s33, s33, 4
    v_add_u32 v8, s33, v8
    s_movk_i32 s33, 2752
    v_mul_lo_u32 v8, v8, s33
    v_and_b32 v9, 3, v1
    v_lshlrev_b32 v9, 7, v9
    v_min_u32 v9, 0x15c, v9
    v_add_u32 v8, v8, v9
    s_mul_i32 s32, s32, 352
    v_add_u32 v8, s32, v8
    v_min_u32 v8, 1409020, v8
    s_cmp_eq_u32 s29, 0
    s_cselect_b32 s34, s12, s14
    s_cselect_b32 s35, s13, s15
    global_load_dword v192, v8, s[34:35]
    s_branch L_l2x
L_l2d:
    s_mul_i32 s33, s33, 43
    v_min_u32 v8, 42, v1
    v_add_u32 v8, s33, v8
    v_lshlrev_b32 v8, 10, v8
    s_lshl_b32 s32, s32, 7
    v_add_u32 v8, s32, v8
    global_load_dword v192, v8, s[16:17]
L_l2x:
    s_waitcnt lgkmcnt(0)
    s_barrier
    s_cmp_eq_u32 s42, 0
    s_cselect_b64 vcc, -1, 0
    s_cbranch_scc1 L_wonow
    s_mov_b32 m0, s54
    s_add_u32 s54, s54, 8192
    global_load_lds_dwordx4 v184, s[52:53]
    s_add_u32 s52, s52, 32768
    s_addc_u32 s53, s53, 0
    s_mov_b32 m0, s54
    s_add_u32 s54, s54, 8192
    global_load_lds_dwordx4 v184, s[52:53]
    s_add_u32 s52, s52, 32768
    s_addc_u32 s53, s53, 0
    s_mov_b32 m0, s54
    s_add_u32 s54, s54, 8192
    global_load_lds_dwordx4 v184, s[52:53]
    s_add_u32 s52, s52, 32768
    s_addc_u32 s53, s53, 0
    s_mov_b32 m0, s54
    s_add_u32 s54, s54, 8192
    global_load_lds_dwordx4 v184, s[52:53]
    s_add_u32 s52, s52, 32768
    s_addc_u32 s53, s53, 0
    s_mov_b32 m0, s54
    s_add_u32 s54, s54, 8192
    global_load_lds_dwordx4 v184, s[52:53]
    s_add_u32 s52, s52, 32768
    s_addc_u32 s53, s53, 0
    s_mov_b32 m0, s54
    s_add_u32 s54, s54, 8192
    global_load_lds_dwordx4 v184, s[52:53]
    s_add_u32 s52, s52, 32768
    s_addc_u32 s53, s53, 0
    s_mov_b32 m0, s54
    s_add_u32 s54, s54, 8192
    global_load_lds_dwordx4 v184, s[52:53]
    s_add_u32 s52, s52, 32768
    s_addc_u32 s53, s53, 0
    s_mov_b32 m0, s54
    s_add_u32 s54, s54, 8192
    global_load_lds_dwordx4 v184, s[52:53]
    s_add_u32 s52, s52, 32768
    s_addc_u32 s53, s53, 0
    s_mov_b32 m0, s54
    s_add_u32 s54, s54, 8192
    global_load_lds_dwordx4 v184, s[52:53]
    s_add_u32 s52, s52, 32768
    s_addc_u32 s53, s53, 0
    s_mov_b32 m0, s54
    s_add_u32 s54, s54, 8192
    global_load_lds_dwordx4 v184, s[52:53]
    s_add_u32 s52, s52, 32768
    s_addc_u32 s53, s53, 0
    s_mov_b32 m0, s54
    s_add_u32 s54, s54, 8192
    global_load_lds_dwordx4 v184, s[52:53]
    s_add_u32 s52, s52, 32768
    s_addc_u32 s53, s53, 0
    s_mov_b32 m0, s54
    s_add_u32 s54, s54, 8192
    global_load_lds_dwordx4 v184, s[52:53]
    s_add_u32 s52, s52, 32768
    s_addc_u32 s53, s53, 0
    s_mov_b32 m0, s54
    s_add_u32 s54, s54, 8192
    global_load_lds_dwordx4 v184, s[52:53]
    s_add_u32 s52, s52, 32768
    s_addc_u32 s53, s53, 0
    s_lshl_b32 s54, s29, 10
    s_add_u32 s54, s54, 32768
    s_mov_b32 m0, s54
    s_add_u32 s54, s54, 8192
    global_load_lds_dwordx4 v184, s[52:53]
    s_add_u32 s52, s52, 32768
    s_addc_u32 s53, s53, 0
    s_mov_b32 m0, s54
    s_add_u32 s54, s54, 8192
    global_load_lds_dwordx4 v184, s[52:53]
    s_add_u32 s52, s52, 32768
    s_addc_u32 s53, s53, 0
    s_mov_b32 m0, s54
    s_add_u32 s54, s54, 8192
    global_load_lds_dwordx4 v184, s[52:53]
    s_add_u32 s52, s52, 32768
    s_addc_u32 s53, s53, 0
L_wonow:
    v_mov_b32 v6, 0xf149f2ca
    v_mov_b32 v7, 0xf149f2ca
    s_cmp_eq_u32 s42, 0
    s_cbranch_scc0 L_p1disp
    v_mfma_f32_32x32x16_bf16 v[68:83], v[16:19], v[2:5], v[132:147]
L_p1A1:
    v_mfma_f32_32x32x16_bf16 v[84:99], v[20:23], v[2:5], 0
    s_cbranch_vccz L_wg_7
    s_mov_b32 m0, s54
    s_add_u32 s54, s54, 8192
    global_load_lds_dwordx4 v184, s[52:53]
    s_add_u32 s52, s52, 32768
    s_addc_u32 s53, s53, 0
L_wg_7:
    s_nop 10
    v_max3_f32 v6, v68, v69, v6
    v_max3_f32 v7, v70, v71, v7
    v_max3_f32 v6, v72, v73, v6
    v_max3_f32 v7, v74, v75, v7
    v_max3_f32 v6, v76, v77, v6
    v_max3_f32 v7, v78, v79, v7
    v_max3_f32 v6, v80, v81, v6
    v_max3_f32 v7, v82, v83, v7
L_p1A2:
    v_mfma_f32_32x32x16_bf16 v[68:83], v[24:27], v[2:5], 0
    s_cbranch_vccz L_wg_8
    s_mov_b32 m0, s54
    s_add_u32 s54, s54, 8192
    global_load_lds_dwordx4 v184, s[52:53]
    s_add_u32 s52, s52, 32768
    s_addc_u32 s53, s53, 0
L_wg_8:
    s_nop 2
    v_max3_f32 v6, v84, v85, v6
    v_max3_f32 v7, v86, v87, v7
    v_max3_f32 v6, v88, v89, v6
    v_max3_f32 v7, v90, v91, v7
    v_max3_f32 v6, v92, v93, v6
    v_max3_f32 v7, v94, v95, v7
    v_max3_f32 v6, v96, v97, v6
    v_max3_f32 v7, v98, v99, v7
L_p1A3:
    v_mfma_f32_32x32x16_bf16 v[84:99], v[28:31], v[2:5], 0
    s_cbranch_vccz L_wg_9
    s_mov_b32 m0, s54
    s_add_u32 s54, s54, 8192
    global_load_lds_dwordx4 v184, s[52:53]
    s_add_u32 s52, s52, 32768
    s_addc_u32 s53, s53, 0
L_wg_9:
    s_nop 2
    v_max3_f32 v6, v68, v69, v6
    v_max3_f32 v7, v70, v71, v7
    v_max3_f32 v6, v72, v73, v6
    v_max3_f32 v7, v74, v75, v7
    v_max3_f32 v6, v76, v77, v6
    v_max3_f32 v7, v78, v79, v7
    v_max3_f32 v6, v80, v81, v6
    v_max3_f32 v7, v82, v83, v7
L_p1A4:
    v_mfma_f32_32x32x16_bf16 v[68:83], v[32:35], v[2:5], 0
    s_cbranch_vccz L_wg_10
    s_mov_b32 m0, s54
    s_add_u32 s54, s54, 8192
    global_load_lds_dwordx4 v184, s[52:53]
    s_add_u32 s52, s52, 32768
    s_addc_u32 s53, s53, 0
L_wg_10:
    s_nop 2
    v_max3_f32 v6, v84, v85, v6
    v_max3_f32 v7, v86, v87, v7
    v_max3_f32 v6, v88, v89, v6
    v_max3_f32 v7, v90, v91, v7
    v_max3_f32 v6, v92, v93, v6
    v_max3_f32 v7, v94, v95, v7
    v_max3_f32 v6, v96, v97, v6
    v_max3_f32 v7, v98, v99, v7
L_p1A5:
    v_mfma_f32_32x32x16_bf16 v[84:99], v[36:39], v[2:5], 0
    s_cbranch_vccz L_wg_11
    s_mov_b32 m0, s54
    s_add_u32 s54, s54, 8192
    global_load_lds_dwordx4 v184, s[52:53]
    s_add_u32 s52, s52, 32768
    s_addc_u32 s53, s53, 0
L_wg_11:
    s_nop 2
    v_max3_f32 v6, v68, v69, v6
    v_max3_f32 v7, v70, v71, v7
    v_max3_f32 v6, v72, v73, v6
    v_max3_f32 v7, v74, v75, v7
    v_max3_f32 v6, v76, v77, v6
    v_max3_f32 v7, v78, v79, v7
    v_max3_f32 v6, v80, v81, v6
    v_max3_f32 v7, v82, v83, v7
L_p1A6:
    v_mfma_f32_32x32x16_bf16 v[68:83], v[40:43], v[2:5], 0
    s_cbranch_vccz L_wg_12
    s_mov_b32 m0, s54
    s_add_u32 s54, s54, 8192
    global_load_lds_dwordx4 v184, s[52:53]
    s_add_u32 s52, s52, 32768
    s_addc_u32 s53, s53, 0
L_wg_12:
    s_nop 2
    v_max3_f32 v6, v84, v85, v6
    v_max3_f32 v7, v86, v87, v7
    v_max3_f32 v6, v88, v89, v6
    v_max3_f32 v7, v90, v91, v7
    v_max3_f32 v6, v92, v93, v6
    v_max3_f32 v7, v94, v95, v7
    v_max3_f32 v6, v96, v97, v6
    v_max3_f32 v7, v98, v99, v7
L_p1A7:
    v_mfma_f32_32x32x16_bf16 v[84:99], v[44:47], v[2:5], 0
    s_cbranch_vccz L_wg_13
    s_mov_b32 m0, s54
    s_add_u32 s54, s54, 8192
    global_load_lds_dwordx4 v184, s[52:53]
    s_add_u32 s52, s52, 32768
    s_addc_u32 s53, s53, 0
L_wg_13:
    s_nop 2
    v_max3_f32 v6, v68, v69, v6
    v_max3_f32 v7, v70, v71, v7
    v_max3_f32 v6, v72, v73, v6
    v_max3_f32 v7, v74, v75, v7
    v_max3_f32 v6, v76, v77, v6
    v_max3_f32 v7, v78, v79, v7
    v_max3_f32 v6, v80, v81, v6
    v_max3_f32 v7, v82, v83, v7
L_p1A8:
    v_mfma_f32_32x32x16_bf16 v[68:83], v[48:51], v[2:5], v[148:163]
    s_cbranch_vccz L_wg_14
    s_mov_b32 m0, s54
    s_add_u32 s54, s54, 8192
    global_load_lds_dwordx4 v184, s[52:53]
    s_add_u32 s52, s52, 32768
    s_addc_u32 s53, s53, 0
L_wg_14:
    s_nop 2
    v_max3_f32 v6, v84, v85, v6
    v_max3_f32 v7, v86, v87, v7
    v_max3_f32 v6, v88, v89, v6
    v_max3_f32 v7, v90, v91, v7
    v_max3_f32 v6, v92, v93, v6
    v_max3_f32 v7, v94, v95, v7
    v_max3_f32 v6, v96, v97, v6
    v_max3_f32 v7, v98, v99, v7
L_p1A9:
    s_nop 3
    v_max3_f32 v6, v68, v69, v6
    v_max3_f32 v7, v70, v71, v7
    v_max3_f32 v6, v72, v73, v6
    v_max3_f32 v7, v74, v75, v7
    v_max3_f32 v6, v76, v77, v6
    v_max3_f32 v7, v78, v79, v7
    v_max3_f32 v6, v80, v81, v6
    v_max3_f32 v7, v82, v83, v7
    s_branch L_p1done
L_p1disp:
    s_cmp_eq_u32 s42, 1
    s_cbranch_scc1 L_p1s1
    s_cmp_eq_u32 s42, 2
    s_cbranch_scc1 L_p1s2
    s_cmp_eq_u32 s42, 3
    s_cbranch_scc1 L_p1s3
    s_cmp_eq_u32 s42, 4
    s_cbranch_scc1 L_p1s4
    s_cmp_eq_u32 s42, 5
    s_cbranch_scc1 L_p1s5
    s_cmp_eq_u32 s42, 6
    s_cbranch_scc1 L_p1s6
    s_cmp_eq_u32 s42, 7
    s_cbranch_scc1 L_p1s7
L_p1s8:
    v_mfma_f32_32x32x16_bf16 v[68:83], v[48:51], v[2:5], v[148:163]
    s_nop 10
    s_branch L_p1A9
L_p1s1:
    v_mfma_f32_32x32x16_bf16 v[84:99], v[20:23], v[2:5], 0
    s_nop 10
    s_branch L_p1A2
L_p1s2:
    v_mfma_f32_32x32x16_bf16 v[68:83], v[24:27], v[2:5], 0
    s_nop 10
    s_branch L_p1A3
L_p1s3:
    v_mfma_f32_32x32x16_bf16 v[84:99], v[28:31], v[2:5], 0
    s_nop 10
    s_branch L_p1A4
L_p1s4:
    v_mfma_f32_32x32x16_bf16 v[68:83], v[32:35], v[2:5], 0
    s_nop 10
    s_branch L_p1A5
L_p1s5:
    v_mfma_f32_32x32x16_bf16 v[84:99], v[36:39], v[2:5], 0
    s_nop 10
    s_branch L_p1A6
L_p1s6:
    v_mfma_f32_32x32x16_bf16 v[68:83], v[40:43], v[2:5], 0
    s_nop 10
    s_branch L_p1A7
L_p1s7:
    v_mfma_f32_32x32x16_bf16 v[84:99], v[44:47], v[2:5], 0
    s_nop 10
    s_branch L_p1A8
L_p1done:
    v_max_f32 v6, v6, v7
    v_mov_b32 v7, v6
    s_nop 1
    v_permlane32_swap_b32 v6, v7
    s_nop 1
    v_max_f32 v6, v6, v7
    v_sub_f32 v6, 0, v6
    v_mov_b32 v116, v6
    v_mov_b32 v117, v6
    v_mov_b32 v118, v6
    v_mov_b32 v119, v6
    v_mov_b32 v120, v6
    v_mov_b32 v121, v6
    v_mov_b32 v122, v6
    v_mov_b32 v123, v6
    v_mov_b32 v124, v6
    v_mov_b32 v125, v6
    v_mov_b32 v126, v6
    v_mov_b32 v127, v6
    v_mov_b32 v128, v6
    v_mov_b32 v129, v6
    v_mov_b32 v130, v6
    v_mov_b32 v131, v6
    v_add_f32 v132, v132, v6
    v_add_f32 v148, v148, v6
    v_add_f32 v133, v133, v6
    v_add_f32 v149, v149, v6
    v_add_f32 v134, v134, v6
    v_add_f32 v150, v150, v6
    v_add_f32 v135, v135, v6
    v_add_f32 v151, v151, v6
    v_add_f32 v136, v136, v6
    v_add_f32 v152, v152, v6
    v_add_f32 v137, v137, v6
    v_add_f32 v153, v153, v6
    v_add_f32 v138, v138, v6
    v_add_f32 v154, v154, v6
    v_add_f32 v139, v139, v6
    v_add_f32 v155, v155, v6
    v_add_f32 v140, v140, v6
    v_add_f32 v156, v156, v6
    v_add_f32 v141, v141, v6
    v_add_f32 v157, v157, v6
    v_add_f32 v142, v142, v6
    v_add_f32 v158, v158, v6
    v_add_f32 v143, v143, v6
    v_add_f32 v159, v159, v6
    v_add_f32 v144, v144, v6
    v_add_f32 v160, v160, v6
    v_add_f32 v145, v145, v6
    v_add_f32 v161, v161, v6
    v_add_f32 v146, v146, v6
    v_add_f32 v162, v162, v6
    v_add_f32 v147, v147, v6
    v_add_f32 v163, v163, v6
    s_mov_b32 s36, 0xffff
    s_mov_b32 s37, 0xffff
    s_nop 1
    s_cmp_eq_u32 s42, 0
    s_cbranch_scc0 L_p2disp
    v_mfma_f32_32x32x16_bf16 v[68:83], v[16:19], v[2:5], v[132:147]
    s_mov_b64 exec, s[36:37]
    ds_read_b128 v[52:55], v187 offset:0
    ds_read_b128 v[56:59], v187 offset:512
    s_mov_b64 exec, -1
L_p2A1:
    v_mfma_f32_32x32x16_bf16 v[84:99], v[20:23], v[2:5], v[116:131]
    s_mov_b64 exec, s[36:37]
    ds_read_b128 v[60:63], v187 offset:2048
    ds_read_b128 v[64:67], v187 offset:2560
    s_mov_b64 exec, -1
    s_cbranch_vccz L_wg_15
    s_mov_b32 m0, s54
    s_add_u32 s54, s54, 8192
    global_load_lds_dwordx4 v184, s[52:53]
    s_add_u32 s52, s52, 32768
    s_addc_u32 s53, s53, 0
L_wg_15:
    s_nop 8
    v_exp_f32 v68, v68
    v_exp_f32 v69, v69
    v_exp_f32 v70, v70
    v_exp_f32 v71, v71
    v_cvt_pk_bf16_f32 v100, v68, v69
    v_exp_f32 v72, v72
    v_exp_f32 v73, v73
    v_cvt_pk_bf16_f32 v101, v70, v71
    v_exp_f32 v74, v74
    v_exp_f32 v75, v75
    v_cvt_pk_bf16_f32 v102, v72, v73
    v_exp_f32 v76, v76
    v_exp_f32 v77, v77
    v_cvt_pk_bf16_f32 v103, v74, v75
    v_exp_f32 v78, v78
    v_exp_f32 v79, v79
    v_cvt_pk_bf16_f32 v104, v76, v77
    v_exp_f32 v80, v80
    v_exp_f32 v81, v81
    v_cvt_pk_bf16_f32 v105, v78, v79
    v_exp_f32 v82, v82
    v_exp_f32 v83, v83
    v_cvt_pk_bf16_f32 v106, v80, v81
    s_nop 0
    v_cvt_pk_bf16_f32 v107, v82, v83
    s_waitcnt lgkmcnt(2)
    s_nop 1
    v_mfma_f32_32x32x16_bf16 v[164:179], v[52:55], v[100:103], v[164:179]
    v_mfma_f32_32x32x16_bf16 v[164:179], v[56:59], v[104:107], v[164:179]
L_p2A2:
    v_mfma_f32_32x32x16_bf16 v[68:83], v[24:27], v[2:5], v[116:131]
    s_mov_b64 exec, s[36:37]
    ds_read_b128 v[52:55], v187 offset:4096
    ds_read_b128 v[56:59], v187 offset:4608
    s_mov_b64 exec, -1
    s_cbranch_vccz L_wg_16
    s_mov_b32 m0, s54
    s_add_u32 s54, s54, 8192
    global_load_lds_dwordx4 v184, s[52:53]
    s_add_u32 s52, s52, 32768
    s_addc_u32 s53, s53, 0
L_wg_16:
    s_nop 0
    v_exp_f32 v84, v84
    v_exp_f32 v85, v85
    v_exp_f32 v86, v86
    v_exp_f32 v87, v87
    v_cvt_pk_bf16_f32 v108, v84, v85
    v_exp_f32 v88, v88
    v_exp_f32 v89, v89
    v_cvt_pk_bf16_f32 v109, v86, v87
    v_exp_f32 v90, v90
    v_exp_f32 v91, v91
    v_cvt_pk_bf16_f32 v110, v88, v89
    v_exp_f32 v92, v92
    v_exp_f32 v93, v93
    v_cvt_pk_bf16_f32 v111, v90, v91
    v_exp_f32 v94, v94
    v_exp_f32 v95, v95
    v_cvt_pk_bf16_f32 v112, v92, v93
    v_exp_f32 v96, v96
    v_exp_f32 v97, v97
    v_cvt_pk_bf16_f32 v113, v94, v95
    v_exp_f32 v98, v98
    v_exp_f32 v99, v99
    v_cvt_pk_bf16_f32 v114, v96, v97
    s_nop 0
    v_cvt_pk_bf16_f32 v115, v98, v99
    s_waitcnt lgkmcnt(2)
    s_nop 1
    v_mfma_f32_32x32x16_bf16 v[164:179], v[60:63], v[108:111], v[164:179]
    v_mfma_f32_32x32x16_bf16 v[164:179], v[64:67], v[112:115], v[164:179]
L_p2A3:
    v_mfma_f32_32x32x16_bf16 v[84:99], v[28:31], v[2:5], v[116:131]
    s_mov_b64 exec, s[36:37]
    ds_read_b128 v[60:63], v187 offset:6144
    ds_read_b128 v[64:67], v187 offset:6656
    s_mov_b64 exec, -1
    s_cbranch_vccz L_wg_17
    s_mov_b32 m0, s54
    s_add_u32 s54, s54, 8192
    global_load_lds_dwordx4 v184, s[52:53]
    s_add_u32 s52, s52, 32768
    s_addc_u32 s53, s53, 0
L_wg_17:
    s_nop 0
    v_exp_f32 v68, v68
    v_exp_f32 v69, v69
    v_exp_f32 v70, v70
    v_exp_f32 v71, v71
    v_cvt_pk_bf16_f32 v100, v68, v69
    v_exp_f32 v72, v72
    v_exp_f32 v73, v73
    v_cvt_pk_bf16_f32 v101, v70, v71
    v_exp_f32 v74, v74
    v_exp_f32 v75, v75
    v_cvt_pk_bf16_f32 v102, v72, v73
    v_exp_f32 v76, v76
    v_exp_f32 v77, v77
    v_cvt_pk_bf16_f32 v103, v74, v75
    v_exp_f32 v78, v78
    v_exp_f32 v79, v79
    v_cvt_pk_bf16_f32 v104, v76, v77
    v_exp_f32 v80, v80
    v_exp_f32 v81, v81
    v_cvt_pk_bf16_f32 v105, v78, v79
    v_exp_f32 v82, v82
    v_exp_f32 v83, v83
    v_cvt_pk_bf16_f32 v106, v80, v81
    s_nop 0
    v_cvt_pk_bf16_f32 v107, v82, v83
    s_waitcnt lgkmcnt(2)
    s_nop 1
    v_mfma_f32_32x32x16_bf16 v[164:179], v[52:55], v[100:103], v[164:179]
    v_mfma_f32_32x32x16_bf16 v[164:179], v[56:59], v[104:107], v[164:179]
L_p2A4:
    v_mfma_f32_32x32x16_bf16 v[68:83], v[32:35], v[2:5], v[116:131]
    s_mov_b64 exec, s[36:37]
    ds_read_b128 v[52:55], v187 offset:8192
    ds_read_b128 v[56:59], v187 offset:8704
    s_mov_b64 exec, -1
    s_cbranch_vccz L_wg_18
    s_mov_b32 m0, s54
    s_add_u32 s54, s54, 8192
    global_load_lds_dwordx4 v184, s[52:53]
    s_add_u32 s52, s52, 32768
    s_addc_u32 s53, s53, 0
L_wg_18:
    s_nop 0
    v_exp_f32 v84, v84
    v_exp_f32 v85, v85
    v_exp_f32 v86, v86
    v_exp_f32 v87, v87
    v_cvt_pk_bf16_f32 v108, v84, v85
    v_exp_f32 v88, v88
    v_exp_f32 v89, v89
    v_cvt_pk_bf16_f32 v109, v86, v87
    v_exp_f32 v90, v90
    v_exp_f32 v91, v91
    v_cvt_pk_bf16_f32 v110, v88, v89
    v_exp_f32 v92, v92
    v_exp_f32 v93, v93
    v_cvt_pk_bf16_f32 v111, v90, v91
    v_exp_f32 v94, v94
    v_exp_f32 v95, v95
    v_cvt_pk_bf16_f32 v112, v92, v93
    v_exp_f32 v96, v96
    v_exp_f32 v97, v97
    v_cvt_pk_bf16_f32 v113, v94, v95
    v_exp_f32 v98, v98
    v_exp_f32 v99, v99
    v_cvt_pk_bf16_f32 v114, v96, v97
    s_nop 0
    v_cvt_pk_bf16_f32 v115, v98, v99
    s_waitcnt lgkmcnt(2)
    s_nop 1
    v_mfma_f32_32x32x16_bf16 v[164:179], v[60:63], v[108:111], v[164:179]
    v_mfma_f32_32x32x16_bf16 v[164:179], v[64:67], v[112:115], v[164:179]
L_p2A5:
    v_mfma_f32_32x32x16_bf16 v[84:99], v[36:39], v[2:5], v[116:131]
    s_mov_b64 exec, s[36:37]
    ds_read_b128 v[60:63], v187 offset:10240
    ds_read_b128 v[64:67], v187 offset:10752
    s_mov_b64 exec, -1
    s_cbranch_vccz L_wg_19
    s_mov_b32 m0, s54
    s_add_u32 s54, s54, 8192
    global_load_lds_dwordx4 v184, s[52:53]
    s_add_u32 s52, s52, 32768
    s_addc_u32 s53, s53, 0
L_wg_19:
    s_nop 0
    v_exp_f32 v68, v68
    v_exp_f32 v69, v69
    v_exp_f32 v70, v70
    v_exp_f32 v71, v71
    v_cvt_pk_bf16_f32 v100, v68, v69
    v_exp_f32 v72, v72
    v_exp_f32 v73, v73
    v_cvt_pk_bf16_f32 v101, v70, v71
    v_exp_f32 v74, v74
    v_exp_f32 v75, v75
    v_cvt_pk_bf16_f32 v102, v72, v73
    v_exp_f32 v76, v76
    v_exp_f32 v77, v77
    v_cvt_pk_bf16_f32 v103, v74, v75
    v_exp_f32 v78, v78
    v_exp_f32 v79, v79
    v_cvt_pk_bf16_f32 v104, v76, v77
    v_exp_f32 v80, v80
    v_exp_f32 v81, v81
    v_cvt_pk_bf16_f32 v105, v78, v79
    v_exp_f32 v82, v82
    v_exp_f32 v83, v83
    v_cvt_pk_bf16_f32 v106, v80, v81
    s_nop 0
    v_cvt_pk_bf16_f32 v107, v82, v83
    s_waitcnt lgkmcnt(2)
    s_nop 1
    v_mfma_f32_32x32x16_bf16 v[164:179], v[52:55], v[100:103], v[164:179]
    v_mfma_f32_32x32x16_bf16 v[164:179], v[56:59], v[104:107], v[164:179]
L_p2A6:
    v_mfma_f32_32x32x16_bf16 v[68:83], v[40:43], v[2:5], v[116:131]
    s_mov_b64 exec, s[36:37]
    ds_read_b128 v[52:55], v187 offset:12288
    ds_read_b128 v[56:59], v187 offset:12800
    s_mov_b64 exec, -1
    s_cbranch_vccz L_wg_20
    s_lshl_b32 s54, s29, 10
    s_add_u32 s54, s54, 32768
    s_mov_b32 m0, s54
    s_add_u32 s54, s54, 8192
    global_load_lds_dwordx4 v184, s[52:53]
    s_add_u32 s52, s52, 32768
    s_addc_u32 s53, s53, 0
L_wg_20:
    s_nop 0
    v_exp_f32 v84, v84
    v_exp_f32 v85, v85
    v_exp_f32 v86, v86
    v_exp_f32 v87, v87
    v_cvt_pk_bf16_f32 v108, v84, v85
    v_exp_f32 v88, v88
    v_exp_f32 v89, v89
    v_cvt_pk_bf16_f32 v109, v86, v87
    v_exp_f32 v90, v90
    v_exp_f32 v91, v91
    v_cvt_pk_bf16_f32 v110, v88, v89
    v_exp_f32 v92, v92
    v_exp_f32 v93, v93
    v_cvt_pk_bf16_f32 v111, v90, v91
    v_exp_f32 v94, v94
    v_exp_f32 v95, v95
    v_cvt_pk_bf16_f32 v112, v92, v93
    v_exp_f32 v96, v96
    v_exp_f32 v97, v97
    v_cvt_pk_bf16_f32 v113, v94, v95
    v_exp_f32 v98, v98
    v_exp_f32 v99, v99
    v_cvt_pk_bf16_f32 v114, v96, v97
    s_nop 0
    v_cvt_pk_bf16_f32 v115, v98, v99
    s_waitcnt lgkmcnt(2)
    s_nop 1
    v_mfma_f32_32x32x16_bf16 v[164:179], v[60:63], v[108:111], v[164:179]
    v_mfma_f32_32x32x16_bf16 v[164:179], v[64:67], v[112:115], v[164:179]
L_p2A7:
    v_mfma_f32_32x32x16_bf16 v[84:99], v[44:47], v[2:5], v[116:131]
    s_mov_b64 exec, s[36:37]
    ds_read_b128 v[60:63], v187 offset:14336
    ds_read_b128 v[64:67], v187 offset:14848
    s_mov_b64 exec, -1
    s_cbranch_vccz L_wg_21
    s_mov_b32 m0, s54
    s_add_u32 s54, s54, 8192
    global_load_lds_dwordx4 v184, s[52:53]
    s_add_u32 s52, s52, 32768
    s_addc_u32 s53, s53, 0
L_wg_21:
    s_nop 0
    v_exp_f32 v68, v68
    v_exp_f32 v69, v69
    v_exp_f32 v70, v70
    v_exp_f32 v71, v71
    v_cvt_pk_bf16_f32 v100, v68, v69
    v_exp_f32 v72, v72
    v_exp_f32 v73, v73
    v_cvt_pk_bf16_f32 v101, v70, v71
    v_exp_f32 v74, v74
    v_exp_f32 v75, v75
    v_cvt_pk_bf16_f32 v102, v72, v73
    v_exp_f32 v76, v76
    v_exp_f32 v77, v77
    v_cvt_pk_bf16_f32 v103, v74, v75
    v_exp_f32 v78, v78
    v_exp_f32 v79, v79
    v_cvt_pk_bf16_f32 v104, v76, v77
    v_exp_f32 v80, v80
    v_exp_f32 v81, v81
    v_cvt_pk_bf16_f32 v105, v78, v79
    v_exp_f32 v82, v82
    v_exp_f32 v83, v83
    v_cvt_pk_bf16_f32 v106, v80, v81
    s_nop 0
    v_cvt_pk_bf16_f32 v107, v82, v83
    s_waitcnt lgkmcnt(2)
    s_nop 1
    v_mfma_f32_32x32x16_bf16 v[164:179], v[52:55], v[100:103], v[164:179]
    v_mfma_f32_32x32x16_bf16 v[164:179], v[56:59], v[104:107], v[164:179]
L_p2A8:
    v_mfma_f32_32x32x16_bf16 v[68:83], v[48:51], v[2:5], v[148:163]
    s_mov_b64 exec, s[36:37]
    ds_read_b128 v[52:55], v187 offset:16384
    ds_read_b128 v[56:59], v187 offset:16896
    s_mov_b64 exec, -1
    s_cbranch_vccz L_wg_22
    s_mov_b32 m0, s54
    s_add_u32 s54, s54, 8192
    global_load_lds_dwordx4 v184, s[52:53]
    s_add_u32 s52, s52, 32768
    s_addc_u32 s53, s53, 0
L_wg_22:
    s_nop 0
    v_exp_f32 v84, v84
    v_exp_f32 v85, v85
    v_exp_f32 v86, v86
    v_exp_f32 v87, v87
    v_cvt_pk_bf16_f32 v108, v84, v85
    v_exp_f32 v88, v88
    v_exp_f32 v89, v89
    v_cvt_pk_bf16_f32 v109, v86, v87
    v_exp_f32 v90, v90
    v_exp_f32 v91, v91
    v_cvt_pk_bf16_f32 v110, v88, v89
    v_exp_f32 v92, v92
    v_exp_f32 v93, v93
    v_cvt_pk_bf16_f32 v111, v90, v91
    v_exp_f32 v94, v94
    v_exp_f32 v95, v95
    v_cvt_pk_bf16_f32 v112, v92, v93
    v_exp_f32 v96, v96
    v_exp_f32 v97, v97
    v_cvt_pk_bf16_f32 v113, v94, v95
    v_exp_f32 v98, v98
    v_exp_f32 v99, v99
    v_cvt_pk_bf16_f32 v114, v96, v97
    s_nop 0
    v_cvt_pk_bf16_f32 v115, v98, v99
    s_waitcnt lgkmcnt(2)
    s_nop 1
    v_mfma_f32_32x32x16_bf16 v[164:179], v[60:63], v[108:111], v[164:179]
    v_mfma_f32_32x32x16_bf16 v[164:179], v[64:67], v[112:115], v[164:179]
L_p2A9:
    s_nop 8
    v_exp_f32 v68, v68
    v_exp_f32 v69, v69
    v_exp_f32 v70, v70
    v_exp_f32 v71, v71
    v_cvt_pk_bf16_f32 v100, v68, v69
    v_exp_f32 v72, v72
    v_exp_f32 v73, v73
    v_cvt_pk_bf16_f32 v101, v70, v71
    v_exp_f32 v74, v74
    v_exp_f32 v75, v75
    v_cvt_pk_bf16_f32 v102, v72, v73
    v_exp_f32 v76, v76
    v_exp_f32 v77, v77
    v_cvt_pk_bf16_f32 v103, v74, v75
    v_exp_f32 v78, v78
    v_exp_f32 v79, v79
    v_cvt_pk_bf16_f32 v104, v76, v77
    v_exp_f32 v80, v80
    v_exp_f32 v81, v81
    v_cvt_pk_bf16_f32 v105, v78, v79
    v_exp_f32 v82, v82
    v_exp_f32 v83, v83
    v_cvt_pk_bf16_f32 v106, v80, v81
    s_nop 0
    v_cvt_pk_bf16_f32 v107, v82, v83
    s_waitcnt lgkmcnt(0)
    s_nop 1
    v_mfma_f32_32x32x16_bf16 v[164:179], v[52:55], v[100:103], v[164:179]
    v_mfma_f32_32x32x16_bf16 v[164:179], v[56:59], v[104:107], v[164:179]
    s_branch L_p2done
L_p2disp:
    s_cmp_eq_u32 s42, 1
    s_cbranch_scc1 L_p2s1
    s_cmp_eq_u32 s42, 2
    s_cbranch_scc1 L_p2s2
    s_cmp_eq_u32 s42, 3
    s_cbranch_scc1 L_p2s3
    s_cmp_eq_u32 s42, 4
    s_cbranch_scc1 L_p2s4
    s_cmp_eq_u32 s42, 5
    s_cbranch_scc1 L_p2s5
    s_cmp_eq_u32 s42, 6
    s_cbranch_scc1 L_p2s6
    s_cmp_eq_u32 s42, 7
    s_cbranch_scc1 L_p2s7
L_p2s8:
    v_mfma_f32_32x32x16_bf16 v[68:83], v[48:51], v[2:5], v[148:163]
    s_mov_b64 exec, s[36:37]
    ds_read_b128 v[52:55], v187 offset:16384
    ds_read_b128 v[56:59], v187 offset:16896
    s_mov_b64 exec, -1
    s_nop 8
    s_branch L_p2A9
L_p2s1:
    v_mfma_f32_32x32x16_bf16 v[84:99], v[20:23], v[2:5], v[116:131]
    s_mov_b64 exec, s[36:37]
    ds_read_b128 v[60:63], v187 offset:2048
    ds_read_b128 v[64:67], v187 offset:2560
    s_mov_b64 exec, -1
    s_nop 8
    s_branch L_p2A2
L_p2s2:
    v_mfma_f32_32x32x16_bf16 v[68:83], v[24:27], v[2:5], v[116:131]
    s_mov_b64 exec, s[36:37]
    ds_read_b128 v[52:55], v187 offset:4096
    ds_read_b128 v[56:59], v187 offset:4608
    s_mov_b64 exec, -1
    s_nop 8
    s_branch L_p2A3
L_p2s3:
    v_mfma_f32_32x32x16_bf16 v[84:99], v[28:31], v[2:5], v[116:131]
    s_mov_b64 exec, s[36:37]
    ds_read_b128 v[60:63], v187 offset:6144
    ds_read_b128 v[64:67], v187 offset:6656
    s_mov_b64 exec, -1
    s_nop 8
    s_branch L_p2A4
L_p2s4:
    v_mfma_f32_32x32x16_bf16 v[68:83], v[32:35], v[2:5], v[116:131]
    s_mov_b64 exec, s[36:37]
    ds_read_b128 v[52:55], v187 offset:8192
    ds_read_b128 v[56:59], v187 offset:8704
    s_mov_b64 exec, -1
    s_nop 8
    s_branch L_p2A5
L_p2s5:
    v_mfma_f32_32x32x16_bf16 v[84:99], v[36:39], v[2:5], v[116:131]
    s_mov_b64 exec, s[36:37]
    ds_read_b128 v[60:63], v187 offset:10240
    ds_read_b128 v[64:67], v187 offset:10752
    s_mov_b64 exec, -1
    s_nop 8
    s_branch L_p2A6
L_p2s6:
    v_mfma_f32_32x32x16_bf16 v[68:83], v[40:43], v[2:5], v[116:131]
    s_mov_b64 exec, s[36:37]
    ds_read_b128 v[52:55], v187 offset:12288
    ds_read_b128 v[56:59], v187 offset:12800
    s_mov_b64 exec, -1
    s_nop 8
    s_branch L_p2A7
L_p2s7:
    v_mfma_f32_32x32x16_bf16 v[84:99], v[44:47], v[2:5], v[116:131]
    s_mov_b64 exec, s[36:37]
    ds_read_b128 v[60:63], v187 offset:14336
    ds_read_b128 v[64:67], v187 offset:14848
    s_mov_b64 exec, -1
    s_nop 8
    s_branch L_p2A8
L_p2done:
    s_nop 15
    v_rcp_f32 v6, v172
    s_nop 0
    v_mul_f32 v164, v164, v6
    v_mul_f32 v165, v165, v6
    v_mul_f32 v166, v166, v6
    v_mul_f32 v167, v167, v6
    v_mul_f32 v168, v168, v6
    v_mul_f32 v169, v169, v6
    v_mul_f32 v170, v170, v6
    v_mul_f32 v171, v171, v6
    v_cvt_pk_bf16_f32 v8, v164, v165
    v_cvt_pk_bf16_f32 v9, v166, v167
    v_cvt_pk_bf16_f32 v10, v168, v169
    v_cvt_pk_bf16_f32 v11, v170, v171
    s_lshl_b32 s32, s43, 5
    s_lshl_b32 s33, s28, 1
    s_add_u32 s32, s32, s33
    s_add_u32 s32, s32, s31
    s_lshl_b32 s33, s32, 10
    s_add_u32 s33, s33, 5242880
    v_lshlrev_b32 v6, 4, v1
    v_add_u32 v6, s33, v6
    global_store_dwordx4 v6, v[8:11], s[24:25] sc1
    s_lshl_b32 s32, s32, 3
    s_add_u32 s32, s32, 49152
    v_mov_b32 v20, s32
    v_mov_b32 v22, s26
    v_mov_b32 v23, s26
    v_lshlrev_b32 v6, 1, v0
    global_load_ushort v14, v6, s[10:11]
    v_lshlrev_b32 v6, 3, v0
    v_add_u32 v6, 8192, v6
    v_add_u32 v7, 8192, v6
    v_add_u32 v18, 4096, v7
    global_load_dwordx2 v[8:9], v6, s[24:25] sc1
    global_load_dwordx2 v[10:11], v7, s[24:25] offset:-4096 sc1
    global_load_dwordx2 v[12:13], v7, s[24:25] sc1
    global_load_dwordx2 v[16:17], v18, s[24:25] sc1
    s_waitcnt vmcnt(5)
    s_mov_b64 exec, 1
    global_store_dwordx2 v20, v[22:23], s[24:25] sc1
    s_mov_b64 exec, -1
    s_waitcnt vmcnt(1)
    v_cmp_ne_u32 vcc, s26, v9
    v_cmp_ne_u32 s[34:35], s26, v11
    s_or_b64 vcc, vcc, s[34:35]
    v_cmp_ne_u32 s[34:35], s26, v13
    s_or_b64 vcc, vcc, s[34:35]
    v_cmp_ne_u32 s[34:35], s26, v17
    s_or_b64 vcc, vcc, s[34:35]
    s_cbranch_vccz L_m2ok
    s_mov_b32 s64, 200000
L_poll_23:
    global_load_dwordx2 v[8:9], v6, s[24:25] sc1
    global_load_dwordx2 v[10:11], v7, s[24:25] offset:-4096 sc1
    global_load_dwordx2 v[12:13], v7, s[24:25] sc1
    global_load_dwordx2 v[16:17], v18, s[24:25] sc1
    s_waitcnt vmcnt(0)
    v_cmp_ne_u32 vcc, s26, v9
    v_cmp_ne_u32 s[66:67], s26, v11
    s_or_b64 vcc, vcc, s[66:67]
    v_cmp_ne_u32 s[66:67], s26, v13
    s_or_b64 vcc, vcc, s[66:67]
    v_cmp_ne_u32 s[66:67], s26, v17
    s_or_b64 vcc, vcc, s[66:67]
    s_cbranch_vccz L_polld_24
    s_sub_u32 s64, s64, 1
    s_cbranch_scc0 L_poll_23
L_polld_24:
L_m2ok:
    v_lshlrev_b32 v14, 16, v14
    v_add_f32 v12, 1.0, v12
    v_cvt_pk_bf16_f32 v12, v12, v12
    v_and_b32 v12, 0xffff0000, v12
    v_mul_f32 v18, v12, v14
    v_mul_f32 v19, v10, v14
    v_lshrrev_b32 v6, 7, v0
    v_cmp_eq_u32 vcc, s40, v6
    s_and_saveexec_b64 s[32:33], vcc
    v_and_b32 v6, 127, v0
    v_lshlrev_b32 v6, 2, v6
    ds_write_b32 v6, v8 offset:5120
    ds_write_b32 v6, v12 offset:5632
    ds_write_b32 v6, v10 offset:6144
    ds_write_b32 v6, v16 offset:6656
    ds_write_b32 v6, v18 offset:7168
    s_mov_b64 exec, s[32:33]
    s_nop 1
    v_add_f32_dpp v18, v18, v18 quad_perm:[1,0,3,2] row_mask:0xf bank_mask:0xf
    v_add_f32_dpp v19, v19, v19 quad_perm:[1,0,3,2] row_mask:0xf bank_mask:0xf
    s_nop 1
    v_add_f32_dpp v18, v18, v18 quad_perm:[2,3,0,1] row_mask:0xf bank_mask:0xf
    v_add_f32_dpp v19, v19, v19 quad_perm:[2,3,0,1] row_mask:0xf bank_mask:0xf
    s_nop 1
    v_add_f32_dpp v18, v18, v18 row_half_mirror row_mask:0xf bank_mask:0xf
    v_add_f32_dpp v19, v19, v19 row_half_mirror row_mask:0xf bank_mask:0xf
    s_nop 1
    v_add_f32_dpp v18, v18, v18 row_mirror row_mask:0xf bank_mask:0xf
    v_add_f32_dpp v19, v19, v19 row_mirror row_mask:0xf bank_mask:0xf
    s_nop 0
    v_mov_b32 v20, v18
    v_mov_b32 v21, v19
    s_nop 1
    v_permlane16_swap_b32 v18, v20
    v_permlane16_swap_b32 v19, v21
    s_nop 1
    v_add_f32 v18, v18, v20
    v_add_f32 v19, v19, v21
    s_nop 0
    v_mov_b32 v20, v18
    v_mov_b32 v21, v19
    s_nop 1
    v_permlane32_swap_b32 v18, v20
    v_permlane32_swap_b32 v19, v21
    s_nop 1
    v_add_f32 v18, v18, v20
    v_add_f32 v19, v19, v21
    s_lshl_b32 s32, s29, 3
    v_mov_b32 v6, s32
    s_mov_b64 exec, 1
    ds_write_b64 v6, v[18:19] offset:7680
    s_mov_b64 exec, -1
    s_waitcnt lgkmcnt(0)
    s_barrier
    v_add_u32 v189, 32768, v188
    v_add_u32 v190, 65536, v188
    v_add_u32 v191, 98304, v188
    v_add_u32 v187, -24576, v188
    ds_read_b64_tr_b16 v[192:193], v188 offset:0
    ds_read_b64_tr_b16 v[194:195], v188 offset:2048
    ds_read_b64_tr_b16 v[196:197], v188 offset:8192
    ds_read_b64_tr_b16 v[198:199], v188 offset:10240
    ds_read_b64_tr_b16 v[200:201], v188 offset:16384
    ds_read_b64_tr_b16 v[202:203], v188 offset:18432
    ds_read_b64_tr_b16 v[204:205], v188 offset:24576
    ds_read_b64_tr_b16 v[206:207], v188 offset:26624
    ds_read_b64_tr_b16 v[208:209], v189 offset:0
    ds_read_b64_tr_b16 v[210:211], v189 offset:2048
    ds_read_b64_tr_b16 v[212:213], v189 offset:8192
    ds_read_b64_tr_b16 v[214:215], v189 offset:10240
    ds_read_b64_tr_b16 v[216:217], v189 offset:16384
    ds_read_b64_tr_b16 v[218:219], v189 offset:18432
    s_waitcnt lgkmcnt(6)
    ds_read_b64_tr_b16 v[220:221], v189 offset:24576
    ds_read_b64_tr_b16 v[222:223], v189 offset:26624
    ds_read_b64_tr_b16 v[224:225], v190 offset:0
    ds_read_b64_tr_b16 v[226:227], v190 offset:2048
    ds_read_b64_tr_b16 v[228:229], v190 offset:8192
    ds_read_b64_tr_b16 v[230:231], v190 offset:10240
    ds_read_b64_tr_b16 v[232:233], v190 offset:16384
    ds_read_b64_tr_b16 v[234:235], v190 offset:18432
    s_waitcnt lgkmcnt(6)
    ds_read_b64_tr_b16 v[236:237], v190 offset:24576
    ds_read_b64_tr_b16 v[238:239], v190 offset:26624
    ds_read_b64_tr_b16 v[240:241], v191 offset:0
    ds_read_b64_tr_b16 v[242:243], v191 offset:2048
    ds_read_b64_tr_b16 v[244:245], v187 offset:0
    ds_read_b64_tr_b16 v[246:247], v187 offset:2048
    s_waitcnt lgkmcnt(6)
    ds_read_b64_tr_b16 v[248:249], v187 offset:8192
    ds_read_b64_tr_b16 v[250:251], v187 offset:10240
    ds_read_b64_tr_b16 v[252:253], v187 offset:16384
    ds_read_b64_tr_b16 v[254:255], v187 offset:18432
    s_waitcnt lgkmcnt(0)
    s_barrier
    s_lshl_b32 s32, s41, 5
    s_lshl_b32 s33, s29, 2
    s_add_u32 s32, s32, s33
    s_lshl_b32 s33, s32, 3
    s_add_u32 s33, s33, 49152
    v_and_b32 v6, 3, v1
    v_lshlrev_b32 v6, 3, v6
    v_add_u32 v6, s33, v6
    s_lshl_b32 s32, s32, 10
    s_add_u32 s32, s32, 5242880
    v_lshlrev_b32 v7, 4, v1
    v_add_u32 v10, s32, v7
    s_lshl_b32 s32, s29, 12
    s_add_u32 m0, s32, 90112
    s_mov_b32 s64, 200000
L_poll_25:
    global_load_dwordx2 v[8:9], v6, s[24:25] sc1
    s_waitcnt vmcnt(0)
    v_cmp_ne_u32 vcc, s26, v9
    s_cbranch_vccz L_polld_26
    s_sub_u32 s64, s64, 1
    s_cbranch_scc0 L_poll_25
L_polld_26:
    global_load_lds_dwordx4 v10, s[24:25] offset:0 sc1
    global_load_lds_dwordx4 v10, s[24:25] offset:1024 sc1
    global_load_lds_dwordx4 v10, s[24:25] offset:2048 sc1
    global_load_lds_dwordx4 v10, s[24:25] offset:3072 sc1
    v_lshrrev_b32 v6, 5, v1
    v_lshlrev_b32 v6, 6, v6
    s_lshl_b32 s32, s30, 7
    s_lshl_b32 s33, s31, 5
    s_add_u32 s32, s32, s33
    v_add_u32 v6, s32, v6
    ds_read_b128 v[104:107], v6 offset:5120
    ds_read_b128 v[108:111], v6 offset:5136
    ds_read_b128 v[112:115], v6 offset:5632
    ds_read_b128 v[116:119], v6 offset:5648
    ds_read_b128 v[120:123], v6 offset:6144
    ds_read_b128 v[124:127], v6 offset:6160
    ds_read_b128 v[128:131], v6 offset:6656
    ds_read_b128 v[132:135], v6 offset:6672
    ds_read_b128 v[136:139], v6 offset:7168
    ds_read_b128 v[140:143], v6 offset:7184
    v_mov_b32 v6, 0
    ds_read_b128 v[156:159], v6 offset:7680
    ds_read_b128 v[160:163], v6 offset:7696
    ds_read_b128 v[164:167], v6 offset:7712
    ds_read_b128 v[168:171], v6 offset:7728
    s_lshl_b32 s32, s31, 10
    s_add_u32 s32, s32, 90112
    v_add_u32 v11, s32, v7
    s_waitcnt lgkmcnt(0)
    v_add_f32 v156, v156, v158
    v_add_f32 v157, v157, v159
    v_add_f32 v156, v156, v160
    v_add_f32 v157, v157, v161
    v_add_f32 v156, v156, v162
    v_add_f32 v157, v157, v163
    v_add_f32 v156, v156, v164
    v_add_f32 v157, v157, v165
    v_add_f32 v156, v156, v166
    v_add_f32 v157, v157, v167
    v_add_f32 v156, v156, v168
    v_add_f32 v157, v157, v169
    v_add_f32 v156, v156, v170
    v_add_f32 v157, v157, v171
    v_mov_b32 v80, 0
    v_mov_b32 v81, 0
    v_mov_b32 v82, 0
    v_mov_b32 v83, 0
    v_mov_b32 v84, 0
    v_mov_b32 v85, 0
    v_mov_b32 v86, 0
    v_mov_b32 v87, 0
    v_mov_b32 v88, 0
    v_mov_b32 v89, 0
    v_mov_b32 v90, 0
    v_mov_b32 v91, 0
    v_mov_b32 v92, 0
    v_mov_b32 v93, 0
    v_mov_b32 v94, 0
    v_mov_b32 v95, 0
    s_waitcnt vmcnt(0)
    s_barrier
    ds_read_b128 v[16:19], v11 offset:0
    ds_read_b128 v[20:23], v11 offset:2048
    ds_read_b128 v[24:27], v11 offset:4096
    ds_read_b128 v[28:31], v11 offset:6144
    ds_read_b128 v[32:35], v11 offset:8192
    ds_read_b128 v[36:39], v11 offset:10240
    ds_read_b128 v[40:43], v11 offset:12288
    ds_read_b128 v[44:47], v11 offset:14336
    s_waitcnt lgkmcnt(0)
    ds_read_b128 v[48:51], v11 offset:16384
    ds_read_b128 v[52:55], v11 offset:18432
    ds_read_b128 v[56:59], v11 offset:20480
    ds_read_b128 v[60:63], v11 offset:22528
    ds_read_b128 v[64:67], v11 offset:24576
    ds_read_b128 v[68:71], v11 offset:26624
    ds_read_b128 v[72:75], v11 offset:28672
    ds_read_b128 v[76:79], v11 offset:30720
    v_mfma_f32_32x32x16_bf16 v[80:95], v[192:195], v[16:19], v[80:95]
    v_mfma_f32_32x32x16_bf16 v[80:95], v[196:199], v[20:23], v[80:95]
    v_mfma_f32_32x32x16_bf16 v[80:95], v[200:203], v[24:27], v[80:95]
    v_mfma_f32_32x32x16_bf16 v[80:95], v[204:207], v[28:31], v[80:95]
    v_mfma_f32_32x32x16_bf16 v[80:95], v[208:211], v[32:35], v[80:95]
    v_mfma_f32_32x32x16_bf16 v[80:95], v[212:215], v[36:39], v[80:95]
    v_mfma_f32_32x32x16_bf16 v[80:95], v[216:219], v[40:43], v[80:95]
    v_mfma_f32_32x32x16_bf16 v[80:95], v[220:223], v[44:47], v[80:95]
    s_cmp_eq_u32 s57, 1
    s_cbranch_scc1 L_pfG
    s_cmp_eq_u32 s57, 2
    s_cbranch_scc0 L_pfX
    v_lshrrev_b32 v8, 1, v1
    v_lshlrev_b32 v8, 10, v8
    v_and_b32 v9, 1, v1
    v_lshlrev_b32 v9, 4, v9
    v_add_u32 v8, v8, v9
    s_lshl_b32 s32, s56, 5
    s_lshl_b32 s33, s29, 15
    s_add_u32 s32, s32, s33
    s_add_u32 s34, s16, s32
    s_addc_u32 s35, s17, 0
    s_lshl_b32 s32, s29, 10
    s_add_u32 m0, s32, 122880
    s_nop 0
    global_load_lds_dwordx4 v8, s[34:35]
    s_add_u32 s34, s34, 262144
    s_addc_u32 s35, s35, 0
    s_add_u32 m0, m0, 8192
    s_nop 0
    global_load_lds_dwordx4 v8, s[34:35]
    s_add_u32 s34, s34, 262144
    s_addc_u32 s35, s35, 0
    s_add_u32 m0, m0, 8192
    s_nop 0
    global_load_lds_dwordx4 v8, s[34:35]
    s_add_u32 s34, s34, 262144
    s_addc_u32 s35, s35, 0
    s_add_u32 m0, m0, 8192
    s_nop 0
    global_load_lds_dwordx4 v8, s[34:35]
    s_add_u32 s34, s34, 262144
    s_addc_u32 s35, s35, 0
    s_add_u32 m0, m0, 8192
    s_nop 0
    global_load_lds_dwordx4 v8, s[34:35]
    s_add_u32 s34, s34, 262144
    s_addc_u32 s35, s35, 0
    s_add_u32 m0, m0, 8192
    s_cmp_lt_u32 s29, 3
    s_cbranch_scc0 L_pfX
    s_lshl_b32 m0, s29, 10
    s_nop 0
    global_load_lds_dwordx4 v8, s[34:35]
    s_branch L_pfX
L_pfG:
    v_lshrrev_b32 v8, 1, v1
    s_movk_i32 s32, 2752
    v_mul_lo_u32 v8, v8, s32
    v_and_b32 v9, 1, v1
    v_lshlrev_b32 v9, 4, v9
    v_add_u32 v8, v8, v9
    s_mul_i32 s32, s29, 176128
    s_lshl_b32 s33, s56, 5
    s_add_u32 s32, s32, s33
    s_lshl_b32 s33, s29, 11
    s_add_u32 s34, s12, s32
    s_addc_u32 s35, s13, 0
    s_add_u32 m0, s33, 122880
    s_nop 0
    global_load_lds_dwordx4 v8, s[34:35]
    s_add_u32 s34, s34, 88064
    s_addc_u32 s35, s35, 0
    s_add_u32 m0, m0, 1024
    s_nop 0
    global_load_lds_dwordx4 v8, s[34:35]
    s_add_u32 s34, s14, s32
    s_addc_u32 s35, s15, 0
    s_add_u32 m0, s33, 139264
    s_nop 0
    global_load_lds_dwordx4 v8, s[34:35]
    s_add_u32 s34, s34, 88064
    s_addc_u32 s35, s35, 0
    s_add_u32 m0, m0, 1024
    s_nop 0
    global_load_lds_dwordx4 v8, s[34:35]
L_pfX:
    s_waitcnt lgkmcnt(0)
    v_mfma_f32_32x32x16_bf16 v[80:95], v[224:227], v[48:51], v[80:95]
    v_mfma_f32_32x32x16_bf16 v[80:95], v[228:231], v[52:55], v[80:95]
    v_mfma_f32_32x32x16_bf16 v[80:95], v[232:235], v[56:59], v[80:95]
    v_mfma_f32_32x32x16_bf16 v[80:95], v[236:239], v[60:63], v[80:95]
    v_mfma_f32_32x32x16_bf16 v[80:95], v[240:243], v[64:67], v[80:95]
    v_mfma_f32_32x32x16_bf16 v[80:95], v[244:247], v[68:71], v[80:95]
    v_mfma_f32_32x32x16_bf16 v[80:95], v[248:251], v[72:75], v[80:95]
    v_mfma_f32_32x32x16_bf16 v[80:95], v[252:255], v[76:79], v[80:95]
    s_lshl_b32 s32, s29, 11
    s_add_u32 s32, s32, 8192
    v_add_u32 v8, s32, v7
    s_xor_b32 s32, s29, 4
    s_lshl_b32 s32, s32, 11
    s_add_u32 s32, s32, 8192
    v_add_u32 v9, s32, v7
    v_lshlrev_b32 v160, 16, v180
    v_and_b32 v161, 0xffff0000, v180
    v_lshlrev_b32 v162, 16, v181
    v_and_b32 v163, 0xffff0000, v181
    v_lshlrev_b32 v164, 16, v182
    v_and_b32 v165, 0xffff0000, v182
    v_lshlrev_b32 v166, 16, v183
    v_and_b32 v167, 0xffff0000, v183
    s_nop 15
    s_cmp_eq_u32 s31, 0
    s_cbranch_scc0 L_p3x1
    ds_write_b128 v8, v[88:91]
    ds_write_b128 v8, v[92:95] offset:1024
    v_mov_b32 v168, v80
    v_mov_b32 v169, v81
    v_mov_b32 v170, v82
    v_mov_b32 v171, v83
    v_mov_b32 v172, v84
    v_mov_b32 v173, v85
    v_mov_b32 v174, v86
    v_mov_b32 v175, v87
    s_branch L_p3x2
L_p3x1:
    ds_write_b128 v8, v[80:83]
    ds_write_b128 v8, v[84:87] offset:1024
    v_mov_b32 v168, v88
    v_mov_b32 v169, v89
    v_mov_b32 v170, v90
    v_mov_b32 v171, v91
    v_mov_b32 v172, v92
    v_mov_b32 v173, v93
    v_mov_b32 v174, v94
    v_mov_b32 v175, v95
L_p3x2:
    s_waitcnt lgkmcnt(0)
    s_barrier
    ds_read_b128 v[96:99], v9
    ds_read_b128 v[100:103], v9 offset:1024
    s_waitcnt lgkmcnt(0)
    v_add_f32 v168, v168, v96
    v_add_f32 v169, v169, v97
    v_add_f32 v170, v170, v98
    v_add_f32 v171, v171, v99
    v_add_f32 v172, v172, v100
    v_add_f32 v173, v173, v101
    v_add_f32 v174, v174, v102
    v_add_f32 v175, v175, v103
    v_cvt_pk_bf16_f32 v96, v168, v169
    v_cvt_pk_bf16_f32 v97, v170, v171
    v_cvt_pk_bf16_f32 v98, v172, v173
    v_cvt_pk_bf16_f32 v99, v174, v175
    v_lshlrev_b32 v168, 16, v96
    v_and_b32 v169, 0xffff0000, v96
    v_lshlrev_b32 v170, 16, v97
    v_and_b32 v171, 0xffff0000, v97
    v_lshlrev_b32 v172, 16, v98
    v_and_b32 v173, 0xffff0000, v98
    v_lshlrev_b32 v174, 16, v99
    v_and_b32 v175, 0xffff0000, v99
    v_mul_f32 v168, v168, v104
    v_mul_f32 v169, v169, v105
    v_mul_f32 v170, v170, v106
    v_mul_f32 v171, v171, v107
    v_mul_f32 v172, v172, v108
    v_mul_f32 v173, v173, v109
    v_mul_f32 v174, v174, v110
    v_mul_f32 v175, v175, v111
    v_cvt_pk_bf16_f32 v96, v168, v169
    v_cvt_pk_bf16_f32 v97, v170, v171
    v_cvt_pk_bf16_f32 v98, v172, v173
    v_cvt_pk_bf16_f32 v99, v174, v175
    v_lshlrev_b32 v168, 16, v96
    v_and_b32 v169, 0xffff0000, v96
    v_lshlrev_b32 v170, 16, v97
    v_and_b32 v171, 0xffff0000, v97
    v_lshlrev_b32 v172, 16, v98
    v_and_b32 v173, 0xffff0000, v98
    v_lshlrev_b32 v174, 16, v99
    v_and_b32 v175, 0xffff0000, v99
    v_add_f32 v168, v168, v160
    v_add_f32 v169, v169, v161
    v_add_f32 v170, v170, v162
    v_add_f32 v171, v171, v163
    v_add_f32 v172, v172, v164
    v_add_f32 v173, v173, v165
    v_add_f32 v174, v174, v166
    v_add_f32 v175, v175, v167
    v_cvt_pk_bf16_f32 v152, v168, v169
    v_cvt_pk_bf16_f32 v153, v170, v171
    v_cvt_pk_bf16_f32 v154, v172, v173
    v_cvt_pk_bf16_f32 v155, v174, v175
    v_lshlrev_b32 v144, 16, v152
    v_and_b32 v145, 0xffff0000, v152
    v_lshlrev_b32 v146, 16, v153
    v_and_b32 v147, 0xffff0000, v153
    v_lshlrev_b32 v148, 16, v154
    v_and_b32 v149, 0xffff0000, v154
    v_lshlrev_b32 v150, 16, v155
    v_and_b32 v151, 0xffff0000, v155
    v_mov_b32 v12, v144
    v_mul_f32 v13, v144, v144
    v_mul_f32 v14, v144, v136
    v_add_f32 v12, v12, v145
    v_fma_f32 v13, v145, v145, v13
    v_fma_f32 v14, v145, v137, v14
    v_add_f32 v12, v12, v146
    v_fma_f32 v13, v146, v146, v13
    v_fma_f32 v14, v146, v138, v14
    v_add_f32 v12, v12, v147
    v_fma_f32 v13, v147, v147, v13
    v_fma_f32 v14, v147, v139, v14
    v_add_f32 v12, v12, v148
    v_fma_f32 v13, v148, v148, v13
    v_fma_f32 v14, v148, v140, v14
    v_add_f32 v12, v12, v149
    v_fma_f32 v13, v149, v149, v13
    v_fma_f32 v14, v149, v141, v14
    v_add_f32 v12, v12, v150
    v_fma_f32 v13, v150, v150, v13
    v_fma_f32 v14, v150, v142, v14
    v_add_f32 v12, v12, v151
    v_fma_f32 v13, v151, v151, v13
    v_fma_f32 v14, v151, v143, v14
    v_mov_b32 v160, v12
    v_mov_b32 v161, v13
    v_mov_b32 v162, v14
    s_nop 1
    v_permlane32_swap_b32 v12, v160
    v_permlane32_swap_b32 v13, v161
    v_permlane32_swap_b32 v14, v162
    s_nop 1
    v_add_f32 v12, v12, v160
    v_add_f32 v13, v13, v161
    v_add_f32 v14, v14, v162
    v_and_b32 v6, 31, v1
    v_lshlrev_b32 v6, 4, v6
    s_lshl_b32 s32, s29, 9
    v_add_u32 v8, s32, v6
    ds_write_b128 v8, v[12:15] offset:24576
    v_lshrrev_b32 v9, 5, v1
    v_lshlrev_b32 v8, 11, v9
    v_add_u32 v8, v8, v6
    s_waitcnt lgkmcnt(0)
    s_barrier
    ds_read_b128 v[160:163], v8 offset:24576
    ds_read_b128 v[164:167], v8 offset:25088
    ds_read_b128 v[168:171], v8 offset:25600
    ds_read_b128 v[172:175], v8 offset:26112
    s_waitcnt lgkmcnt(0)
    v_add_f32 v160, v160, v164
    v_add_f32 v168, v168, v172
    v_add_f32 v12, v160, v168
    v_add_f32 v161, v161, v165
    v_add_f32 v169, v169, v173
    v_add_f32 v13, v161, v169
    v_add_f32 v162, v162, v166
    v_add_f32 v170, v170, v174
    v_add_f32 v14, v162, v170
    v_mov_b32 v160, v12
    v_mov_b32 v161, v13
    v_mov_b32 v162, v14
    s_nop 1
    v_permlane32_swap_b32 v12, v160
    v_permlane32_swap_b32 v13, v161
    v_permlane32_swap_b32 v14, v162
    s_nop 1
    v_add_f32 v12, v12, v160
    v_add_f32 v13, v13, v161
    v_add_f32 v14, v14, v162
    s_lshl_b32 s32, s41, 11
    s_add_u32 s32, s32, 65536
    v_add_u32 v10, s32, v6
    s_lshl_b32 s33, s40, 9
    v_add_u32 v11, s33, v10
    v_mov_b32 v15, s26
    s_cmp_eq_u32 s29, 0
    s_cbranch_scc0 L_p3nopub
    s_mov_b64 exec, 0xffffffff
    global_store_dwordx4 v11, v[12:15], s[24:25] sc1
    s_mov_b64 exec, -1
L_p3nopub:
    v_lshlrev_b32 v9, 10, v9
    v_add_u32 v10, v10, v9
    s_mov_b32 s64, 200000
L_poll_27:
    global_load_dwordx4 v[160:163], v10, s[24:25] sc1
    global_load_dwordx4 v[164:167], v10, s[24:25] offset:512 sc1
    s_waitcnt vmcnt(0)
    v_cmp_ne_u32 vcc, s26, v163
    v_cmp_ne_u32 s[66:67], s26, v167
    s_or_b64 vcc, vcc, s[66:67]
    s_cbranch_vccz L_polld_28
    s_sub_u32 s64, s64, 1
    s_cbranch_scc0 L_poll_27
L_polld_28:
    v_add_f32 v12, v160, v164
    v_add_f32 v13, v161, v165
    v_add_f32 v14, v162, v166
    v_mov_b32 v160, v12
    v_mov_b32 v161, v13
    v_mov_b32 v162, v14
    s_nop 1
    v_permlane32_swap_b32 v12, v160
    v_permlane32_swap_b32 v13, v161
    v_permlane32_swap_b32 v14, v162
    s_nop 1
    v_add_f32 v12, v12, v160
    v_add_f32 v13, v13, v161
    v_add_f32 v14, v14, v162
    v_mul_f32 v12, 0x3b000000, v12
    v_mul_f32 v13, 0x3b000000, v13
    v_fma_f32 v13, -v12, v12, v13
    v_max_f32 v13, 0, v13
    v_add_f32 v13, 0x3727c5ac, v13
    v_rsq_f32 v13, v13
    v_fma_f32 v14, -v12, v156, v14
    v_fma_f32 v14, v14, v13, v157
    v_ashrrev_i32 v15, 31, v14
    v_or_b32 v15, 0x80000000, v15
    v_xor_b32 v15, v15, v14
    v_and_b32 v15, 0xfffff800, v15
    s_lshl_b32 s32, s41, 5
    s_sub_u32 s32, 2047, s32
    v_and_b32 v6, 31, v1
    v_sub_u32 v6, s32, v6
    v_or_b32 v15, v15, v6
    v_mov_b32 v8, v15
    s_nop 1
    v_max_u32_dpp v8, v8, v8 quad_perm:[1,0,3,2] row_mask:0xf bank_mask:0xf
    s_nop 1
    v_max_u32_dpp v8, v8, v8 quad_perm:[2,3,0,1] row_mask:0xf bank_mask:0xf
    s_nop 1
    v_max_u32_dpp v8, v8, v8 row_half_mirror row_mask:0xf bank_mask:0xf
    s_nop 1
    v_max_u32_dpp v8, v8, v8 row_mirror row_mask:0xf bank_mask:0xf
    s_nop 0
    v_mov_b32 v9, v8
    s_nop 1
    v_permlane16_swap_b32 v8, v9
    s_nop 1
    v_max_u32 v8, v8, v9
    v_cmp_eq_u32 vcc, v8, v15
    v_cndmask_b32_e64 v10, v15, 0, vcc
    s_nop 1
    v_max_u32_dpp v10, v10, v10 quad_perm:[1,0,3,2] row_mask:0xf bank_mask:0xf
    s_nop 1
    v_max_u32_dpp v10, v10, v10 quad_perm:[2,3,0,1] row_mask:0xf bank_mask:0xf
    s_nop 1
    v_max_u32_dpp v10, v10, v10 row_half_mirror row_mask:0xf bank_mask:0xf
    s_nop 1
    v_max_u32_dpp v10, v10, v10 row_mirror row_mask:0xf bank_mask:0xf
    s_nop 0
    v_mov_b32 v9, v10
    s_nop 1
    v_permlane16_swap_b32 v10, v9
    s_nop 1
    v_max_u32 v10, v10, v9
    s_or_b32 s32, s29, s40
    s_cmp_eq_u32 s32, 0
    s_cbranch_scc0 L_p3nokey
    v_mov_b32 v160, v8
    v_mov_b32 v161, v10
    v_mov_b32 v162, 0
    v_mov_b32 v163, s26
    s_lshl_b32 s32, s41, 4
    s_add_u32 s32, s32, 196608
    v_mov_b32 v9, s32
    s_mov_b64 exec, 1
    global_store_dwordx4 v9, v[160:163], s[24:25] sc1
    s_mov_b64 exec, -1
L_p3nokey:
    v_mul_f32 v12, v12, v13
    v_sub_f32 v12, 0, v12
    v_fma_f32 v168, v144, v13, v12
    v_fma_f32 v169, v145, v13, v12
    v_fma_f32 v170, v146, v13, v12
    v_fma_f32 v171, v147, v13, v12
    v_fma_f32 v172, v148, v13, v12
    v_fma_f32 v173, v149, v13, v12
    v_fma_f32 v174, v150, v13, v12
    v_fma_f32 v175, v151, v13, v12
    v_fma_f32 v168, v168, v112, v120
    v_fma_f32 v169, v169, v113, v121
    v_fma_f32 v170, v170, v114, v122
    v_fma_f32 v171, v171, v115, v123
    v_fma_f32 v172, v172, v116, v124
    v_fma_f32 v173, v173, v117, v125
    v_fma_f32 v174, v174, v118, v126
    v_fma_f32 v175, v175, v119, v127
    v_cvt_pk_bf16_f32 v96, v168, v169
    v_cvt_pk_bf16_f32 v97, v170, v171
    v_cvt_pk_bf16_f32 v98, v172, v173
    v_cvt_pk_bf16_f32 v99, v174, v175
    v_lshlrev_b32 v168, 16, v96
    v_and_b32 v169, 0xffff0000, v96
    v_lshlrev_b32 v170, 16, v97
    v_and_b32 v171, 0xffff0000, v97
    v_lshlrev_b32 v172, 16, v98
    v_and_b32 v173, 0xffff0000, v98
    v_lshlrev_b32 v174, 16, v99
    v_and_b32 v175, 0xffff0000, v99
    v_cmp_eq_u32 vcc, v8, v15
    v_cmp_eq_u32 s[34:35], v10, v15
    s_or_b64 s[36:37], vcc, s[34:35]
    v_cndmask_b32_e64 v9, 0, 1, s[34:35]
    s_lshl_b32 s32, s41, 1
    v_add_u32 v9, s32, v9
    v_lshlrev_b32 v9, 12, v9
    v_and_b32 v11, 1023, v185
    v_lshlrev_b32 v11, 2, v11
    v_add_u32 v9, v9, v11
    v_add_u32 v9, 262144, v9
    v_and_b32 v104, 0xffff, v96
    v_lshlrev_b32 v11, 16, v152
    v_or_b32 v104, v104, v11
    v_mov_b32 v105, s26
    v_lshrrev_b32 v106, 16, v96
    v_and_b32 v11, 0xffff0000, v152
    v_or_b32 v106, v106, v11
    v_mov_b32 v107, s26
    v_and_b32 v108, 0xffff, v97
    v_lshlrev_b32 v11, 16, v153
    v_or_b32 v108, v108, v11
    v_mov_b32 v109, s26
    v_lshrrev_b32 v110, 16, v97
    v_and_b32 v11, 0xffff0000, v153
    v_or_b32 v110, v110, v11
    v_mov_b32 v111, s26
    v_and_b32 v112, 0xffff, v98
    v_lshlrev_b32 v11, 16, v154
    v_or_b32 v112, v112, v11
    v_mov_b32 v113, s26
    v_lshrrev_b32 v114, 16, v98
    v_and_b32 v11, 0xffff0000, v154
    v_or_b32 v114, v114, v11
    v_mov_b32 v115, s26
    v_and_b32 v116, 0xffff, v99
    v_lshlrev_b32 v11, 16, v155
    v_or_b32 v116, v116, v11
    v_mov_b32 v117, s26
    v_lshrrev_b32 v118, 16, v99
    v_and_b32 v11, 0xffff0000, v155
    v_or_b32 v118, v118, v11
    v_mov_b32 v119, s26
    s_mov_b64 exec, s[36:37]
    global_store_dwordx4 v9, v[104:107], s[24:25] offset:0 sc1
    global_store_dwordx4 v9, v[108:111], s[24:25] offset:16 sc1
    global_store_dwordx4 v9, v[112:115], s[24:25] offset:32 sc1
    global_store_dwordx4 v9, v[116:119], s[24:25] offset:48 sc1
    s_mov_b64 exec, -1
    v_mul_f32 v168, v168, v128
    v_mul_f32 v169, v169, v129
    v_mul_f32 v170, v170, v130
    v_mul_f32 v171, v171, v131
    v_mul_f32 v172, v172, v132
    v_mul_f32 v173, v173, v133
    v_mul_f32 v174, v174, v134
    v_mul_f32 v175, v175, v135
    v_cvt_pk_bf16_f32 v96, v168, v169
    v_cvt_pk_bf16_f32 v97, v170, v171
    v_cvt_pk_bf16_f32 v98, v172, v173
    v_cvt_pk_bf16_f32 v99, v174, v175
    v_lshlrev_b32 v168, 16, v96
    v_and_b32 v169, 0xffff0000, v96
    v_lshlrev_b32 v170, 16, v97
    v_and_b32 v171, 0xffff0000, v97
    v_lshlrev_b32 v172, 16, v98
    v_and_b32 v173, 0xffff0000, v98
    v_lshlrev_b32 v174, 16, v99
    v_and_b32 v175, 0xffff0000, v99
    v_add_f32 v168, v168, v144
    v_add_f32 v169, v169, v145
    v_add_f32 v170, v170, v146
    v_add_f32 v171, v171, v147
    v_add_f32 v172, v172, v148
    v_add_f32 v173, v173, v149
    v_add_f32 v174, v174, v150
    v_add_f32 v175, v175, v151
    v_cvt_pk_bf16_f32 v96, v168, v169
    v_cvt_pk_bf16_f32 v97, v170, v171
    v_cvt_pk_bf16_f32 v98, v172, v173
    v_cvt_pk_bf16_f32 v99, v174, v175
    s_mov_b64 exec, s[36:37]
    global_store_dwordx4 v185, v[96:99], s[22:23] sc1
    s_not_b64 exec, s[36:37]
    global_store_dwordx4 v185, v[96:99], s[22:23]
    s_mov_b64 exec, -1
    s_lshl_b32 s32, s41, 2
    s_add_u32 s32, s32, s40
    s_lshl_b32 s32, s32, 3
    s_add_u32 s32, s32, s29
    s_lshl_b32 s32, s32, 3
    s_add_u32 s32, s32, 212992
    v_mov_b32 v6, s32
    v_mov_b32 v8, s26
    v_mov_b32 v9, s26
    s_waitcnt vmcnt(0)
    s_mov_b64 exec, 1
    global_store_dwordx2 v6, v[8:9], s[24:25] sc1
    s_mov_b64 exec, -1
    s_cmp_eq_u32 s57, 1
    s_cbranch_scc1 L_G
    s_cmp_eq_u32 s57, 2
    s_cbranch_scc0 L_exit
    v_and_b32 v100, 1, v1
    v_mul_u32_u24 v100, 2816, v100
    v_lshrrev_b32 v101, 4, v1
    v_lshlrev_b32 v102, 4, v101
    v_add_u32 v100, v100, v102
    s_lshl_b32 s32, s29, 6
    s_add_u32 s32, s32, 40960
    v_add_u32 v100, s32, v100
    v_lshlrev_b32 v101, 8, v101
    v_bfe_u32 v102, v1, 2, 2
    v_lshlrev_b32 v102, 5, v102
    v_add_u32 v101, v101, v102
    v_and_b32 v102, 3, v1
    v_lshlrev_b32 v102, 3, v102
    v_add_u32 v101, v101, v102
    s_lshl_b32 s32, s29, 10
    v_add_u32 v103, s32, v101
    v_add_u32 v101, 122880, v103
    ds_read_b64_tr_b16 v[44:45], v101 offset:0
    ds_read_b64_tr_b16 v[46:47], v101 offset:128
    ds_read_b64_tr_b16 v[52:53], v101 offset:8192
    ds_read_b64_tr_b16 v[54:55], v101 offset:8320
    ds_read_b64_tr_b16 v[60:61], v101 offset:16384
    ds_read_b64_tr_b16 v[62:63], v101 offset:16512
    ds_read_b64_tr_b16 v[68:69], v101 offset:24576
    ds_read_b64_tr_b16 v[70:71], v101 offset:24704
    ds_read_b64_tr_b16 v[76:77], v101 offset:32768
    ds_read_b64_tr_b16 v[78:79], v101 offset:32896
    ds_read_b64_tr_b16 v[84:85], v103
    ds_read_b64_tr_b16 v[86:87], v103 offset:128
    v_lshlrev_b32 v6, 4, v1
    v_add_u32 v6, 196608, v6
    s_mov_b32 s64, 200000
L_poll_29:
    global_load_dwordx4 v[8:11], v6, s[24:25] sc1
    s_waitcnt vmcnt(0)
    v_cmp_ne_u32 vcc, s26, v11
    s_cbranch_vccz L_polld_30
    s_sub_u32 s64, s64, 1
    s_cbranch_scc0 L_poll_29
L_polld_30:
    v_mov_b32 v12, v8
    s_nop 1
    v_max_u32_dpp v12, v12, v12 quad_perm:[1,0,3,2] row_mask:0xf bank_mask:0xf
    s_nop 1
    v_max_u32_dpp v12, v12, v12 quad_perm:[2,3,0,1] row_mask:0xf bank_mask:0xf
    s_nop 1
    v_max_u32_dpp v12, v12, v12 row_half_mirror row_mask:0xf bank_mask:0xf
    s_nop 1
    v_max_u32_dpp v12, v12, v12 row_mirror row_mask:0xf bank_mask:0xf
    s_nop 0
    v_mov_b32 v13, v12
    s_nop 1
    v_permlane16_swap_b32 v12, v13
    s_nop 1
    v_max_u32 v12, v12, v13
    s_nop 0
    v_mov_b32 v13, v12
    s_nop 1
    v_permlane32_swap_b32 v12, v13
    s_nop 1
    v_max_u32 v12, v12, v13
    v_cmp_eq_u32 vcc, v12, v8
    v_cndmask_b32 v14, v8, v9, vcc
    s_nop 1
    v_max_u32_dpp v14, v14, v14 quad_perm:[1,0,3,2] row_mask:0xf bank_mask:0xf
    s_nop 1
    v_max_u32_dpp v14, v14, v14 quad_perm:[2,3,0,1] row_mask:0xf bank_mask:0xf
    s_nop 1
    v_max_u32_dpp v14, v14, v14 row_half_mirror row_mask:0xf bank_mask:0xf
    s_nop 1
    v_max_u32_dpp v14, v14, v14 row_mirror row_mask:0xf bank_mask:0xf
    s_nop 0
    v_mov_b32 v13, v14
    s_nop 1
    v_permlane16_swap_b32 v14, v13
    s_nop 1
    v_max_u32 v14, v14, v13
    s_nop 0
    v_mov_b32 v13, v14
    s_nop 1
    v_permlane32_swap_b32 v14, v13
    s_nop 1
    v_max_u32 v14, v14, v13
    s_nop 0
    v_readfirstlane_b32 s49, v12
    v_readfirstlane_b32 s50, v14
    s_and_b32 s45, s49, 0x7ff
    s_sub_u32 s45, 2047, s45
    s_and_b32 s46, s50, 0x7ff
    s_sub_u32 s46, 2047, s46
    s_lshr_b32 s47, s45, 5
    s_lshr_b32 s48, s46, 5
    s_cmp_eq_u32 s47, s48
    s_cselect_b32 s32, 1, 0
    s_lshl_b32 s47, s47, 1
    s_lshl_b32 s48, s48, 1
    s_add_u32 s48, s48, s32
    s_mov_b32 s36, s56
    v_bfe_u32 v6, v1, 4, 1
    v_cmp_eq_u32 vcc, 1, v6
    v_mov_b32 v7, s47
    v_mov_b32 v8, s48
    v_cndmask_b32 v20, v7, v8, vcc
    v_mov_b32 v7, s45
    v_mov_b32 v8, s46
    v_cndmask_b32 v21, v7, v8, vcc
    v_mov_b32 v7, s49
    v_mov_b32 v8, s50
    v_cndmask_b32 v22, v7, v8, vcc
    v_and_b32 v23, 15, v1
    s_lshl_b32 s32, s36, 4
    v_add_u32 v23, s32, v23
    v_lshlrev_b32 v24, 12, v20
    v_lshlrev_b32 v25, 3, v23
    v_add_u32 v24, v24, v25
    v_add_u32 v24, 262144, v24
    v_add_u32 v25, 20480, v25
    v_lshrrev_b32 v26, 5, v21
    v_lshlrev_b32 v26, 5, v26
    s_lshr_b32 s32, s36, 3
    s_lshl_b32 s32, s32, 3
    s_bfe_u32 s33, s36, 0x20001
    s_add_u32 s32, s32, s33
    v_add_u32 v26, s32, v26
    v_and_b32 v27, 1, v1
    v_lshlrev_b32 v27, 2, v27
    v_add_u32 v26, v26, v27
    v_lshlrev_b32 v26, 3, v26
    v_add_u32 v26, 212992, v26
    v_and_b32 v22, 0xfffff800, v22
    v_ashrrev_i32 v7, 31, v22
    v_not_b32 v7, v7
    v_or_b32 v7, 0x80000000, v7
    v_xor_b32 v22, v22, v7
    v_cvt_pk_bf16_f32 v22, v22, v22
    v_and_b32 v22, 0xffff0000, v22
    v_mul_f32 v7, 0xbfb8aa3b, v22
    v_exp_f32 v7, v7
    s_nop 0
    v_add_f32 v7, 1.0, v7
    v_rcp_f32 v7, v7
    s_nop 0
    v_cvt_pk_bf16_f32 v7, v7, v7
    v_and_b32 v7, 0xffff0000, v7
    v_mov_b32 v34, v7
    v_lshlrev_b32 v6, 3, v0
    v_add_u32 v6, 229376, v6
    v_add_u32 v7, 4096, v6
    v_min_u32 v8, 351, v0
    v_lshlrev_b32 v8, 3, v8
    v_add_u32 v8, 237568, v8
    s_mov_b32 s64, 200000
L_poll_31:
    global_load_dwordx2 v[28:29], v24, s[24:25] sc1
    global_load_dwordx2 v[30:31], v25, s[24:25] sc1
    global_load_dwordx2 v[32:33], v26, s[24:25] sc1
    s_waitcnt vmcnt(0)
    v_cmp_ne_u32 vcc, s26, v29
    v_cmp_ne_u32 s[66:67], s26, v31
    s_or_b64 vcc, vcc, s[66:67]
    v_cmp_ne_u32 s[66:67], s26, v33
    s_or_b64 vcc, vcc, s[66:67]
    s_cbranch_vccz L_polld_32
    s_sub_u32 s64, s64, 1
    s_cbranch_scc0 L_poll_31
L_polld_32:
    s_mov_b32 s64, 200000
L_poll_33:
    global_load_dwordx2 v[10:11], v6, s[24:25] sc1
    global_load_dwordx2 v[12:13], v7, s[24:25] sc1
    global_load_dwordx2 v[14:15], v8, s[24:25] sc1
    s_waitcnt vmcnt(0)
    v_cmp_ne_u32 vcc, s26, v11
    v_cmp_ne_u32 s[66:67], s26, v13
    s_or_b64 vcc, vcc, s[66:67]
    v_cmp_ne_u32 s[66:67], s26, v15
    s_or_b64 vcc, vcc, s[66:67]
    s_cbranch_vccz L_polld_34
    s_sub_u32 s64, s64, 1
    s_cbranch_scc0 L_poll_33
L_polld_34:
    v_lshlrev_b32 v6, 1, v0
    ds_write_b16 v6, v10 offset:40960
    ds_write_b16_d16_hi v6, v10 offset:43776
    ds_write_b16 v6, v12 offset:41984
    ds_write_b16_d16_hi v6, v12 offset:44800
    v_min_u32 v7, 351, v0
    v_lshlrev_b32 v7, 1, v7
    ds_write_b16 v7, v14 offset:43008
    ds_write_b16_d16_hi v7, v14 offset:45824
    s_cmp_eq_u32 s2, 224
    s_cbranch_scc0 L_nobump
    s_cmp_eq_u32 s29, 0
    s_cbranch_scc0 L_nobump
    s_add_u32 s32, s44, 1
    v_mov_b32 v8, s32
    v_mov_b32 v9, 0
    s_mov_b64 exec, 1
    global_store_dword v9, v8, s[24:25] sc1
    s_mov_b64 exec, -1
L_nobump:
    s_waitcnt lgkmcnt(0)
    s_barrier
    ds_read_b128 v[40:43], v100 offset:0
    ds_read_b128 v[48:51], v100 offset:512
    ds_read_b128 v[56:59], v100 offset:1024
    ds_read_b128 v[64:67], v100 offset:1536
    ds_read_b128 v[72:75], v100 offset:2048
    ds_read_b128 v[80:83], v100 offset:2560
    v_mov_b32 v36, 0
    v_mov_b32 v37, 0
    v_mov_b32 v38, 0
    v_mov_b32 v39, 0
    s_waitcnt lgkmcnt(0)
    v_mfma_f32_16x16x32_bf16 v[36:39], v[40:43], v[44:47], v[36:39]
    v_mfma_f32_16x16x32_bf16 v[36:39], v[48:51], v[52:55], v[36:39]
    v_mfma_f32_16x16x32_bf16 v[36:39], v[56:59], v[60:63], v[36:39]
    v_mfma_f32_16x16x32_bf16 v[36:39], v[64:67], v[68:71], v[36:39]
    v_mfma_f32_16x16x32_bf16 v[36:39], v[72:75], v[76:79], v[36:39]
    s_cmp_lt_u32 s29, 3
    s_cbranch_scc0 L_d6
    v_mfma_f32_16x16x32_bf16 v[36:39], v[80:83], v[84:87], v[36:39]
L_d6:
    v_lshlrev_b32 v6, 3, v1
    s_lshl_b32 s32, s29, 7
    v_add_u32 v6, s32, v6
    s_nop 7
    s_mov_b64 exec, 0xffff
    ds_write_b64 v6, v[36:37] offset:36864
    s_mov_b64 exec, -1
    s_waitcnt lgkmcnt(0)
    s_barrier
    s_cmp_eq_u32 s29, 0
    s_cbranch_scc0 L_exit
    v_and_b32 v6, 15, v1
    v_lshlrev_b32 v6, 3, v6
    v_bfe_u32 v7, v1, 4, 1
    v_lshlrev_b32 v7, 2, v7
    v_add_u32 v6, v6, v7
    ds_read_b32 v40, v6 offset:36864
    ds_read_b32 v41, v6 offset:36992
    ds_read_b32 v42, v6 offset:37120
    ds_read_b32 v43, v6 offset:37248
    ds_read_b32 v44, v6 offset:37376
    ds_read_b32 v45, v6 offset:37504
    ds_read_b32 v46, v6 offset:37632
    ds_read_b32 v47, v6 offset:37760
    s_waitcnt lgkmcnt(0)
    v_add_f32 v40, v40, v41
    v_add_f32 v40, v40, v42
    v_add_f32 v40, v40, v43
    v_add_f32 v40, v40, v44
    v_add_f32 v40, v40, v45
    v_add_f32 v40, v40, v46
    v_add_f32 v40, v40, v47
    v_cvt_pk_bf16_f32 v40, v40, v40
    v_and_b32 v40, 0xffff0000, v40
    v_mul_f32 v40, v40, v34
    v_cvt_pk_bf16_f32 v40, v40, v40
    v_and_b32 v40, 0xffff0000, v40
    v_lshlrev_b32 v8, 16, v28
    v_and_b32 v9, 0xffff0000, v28
    v_add_f32 v40, v40, v8
    v_cvt_pk_bf16_f32 v40, v40, v40
    v_and_b32 v40, 0xffff0000, v40
    v_mul_f32 v40, v40, v30
    v_cvt_pk_bf16_f32 v40, v40, v40
    v_and_b32 v40, 0xffff0000, v40
    v_add_f32 v40, v40, v9
    v_cvt_pk_bf16_f32 v40, v40, v40
    v_lshlrev_b32 v6, 10, v21
    v_lshlrev_b32 v7, 1, v23
    v_add_u32 v6, v6, v7
    s_mov_b64 exec, 0xffffffff
    global_store_short v6, v40, s[22:23] sc1
    s_waitcnt vmcnt(0)
    s_endpgm
L_G:
    v_and_b32 v64, 1, v1
    v_lshlrev_b32 v64, 10, v64
    v_lshrrev_b32 v65, 4, v1
    v_lshlrev_b32 v66, 4, v65
    v_add_u32 v64, v64, v66
    s_lshl_b32 s32, s29, 7
    s_add_u32 s32, s32, 32768
    v_add_u32 v64, s32, v64
    v_lshlrev_b32 v65, 8, v65
    v_bfe_u32 v66, v1, 2, 2
    v_lshlrev_b32 v66, 5, v66
    v_add_u32 v65, v65, v66
    v_and_b32 v66, 3, v1
    v_lshlrev_b32 v66, 3, v66
    v_add_u32 v65, v65, v66
    s_lshl_b32 s32, s29, 11
    s_add_u32 s32, s32, 122880
    v_add_u32 v65, s32, v65
    ds_read_b64_tr_b16 v[40:41], v65 offset:0
    ds_read_b64_tr_b16 v[42:43], v65 offset:128
    ds_read_b64_tr_b16 v[44:45], v65 offset:1024
    ds_read_b64_tr_b16 v[46:47], v65 offset:1152
    ds_read_b64_tr_b16 v[48:49], v65 offset:16384
    ds_read_b64_tr_b16 v[50:51], v65 offset:16512
    ds_read_b64_tr_b16 v[52:53], v65 offset:17408
    ds_read_b64_tr_b16 v[54:55], v65 offset:17536
    v_mov_b32 v32, 0
    v_mov_b32 v33, 0
    v_mov_b32 v34, 0
    v_mov_b32 v35, 0
    v_mov_b32 v36, 0
    v_mov_b32 v37, 0
    v_mov_b32 v38, 0
    v_mov_b32 v39, 0
    v_lshlrev_b32 v6, 4, v1
    v_add_u32 v6, 196608, v6
    s_mov_b32 s64, 200000
L_poll_35:
    global_load_dwordx4 v[8:11], v6, s[24:25] sc1
    s_waitcnt vmcnt(0)
    v_cmp_ne_u32 vcc, s26, v11
    s_cbranch_vccz L_polld_36
    s_sub_u32 s64, s64, 1
    s_cbranch_scc0 L_poll_35
L_polld_36:
    v_mov_b32 v12, v8
    s_nop 1
    v_max_u32_dpp v12, v12, v12 quad_perm:[1,0,3,2] row_mask:0xf bank_mask:0xf
    s_nop 1
    v_max_u32_dpp v12, v12, v12 quad_perm:[2,3,0,1] row_mask:0xf bank_mask:0xf
    s_nop 1
    v_max_u32_dpp v12, v12, v12 row_half_mirror row_mask:0xf bank_mask:0xf
    s_nop 1
    v_max_u32_dpp v12, v12, v12 row_mirror row_mask:0xf bank_mask:0xf
    s_nop 0
    v_mov_b32 v13, v12
    s_nop 1
    v_permlane16_swap_b32 v12, v13
    s_nop 1
    v_max_u32 v12, v12, v13
    s_nop 0
    v_mov_b32 v13, v12
    s_nop 1
    v_permlane32_swap_b32 v12, v13
    s_nop 1
    v_max_u32 v12, v12, v13
    v_cmp_eq_u32 vcc, v12, v8
    v_cndmask_b32 v14, v8, v9, vcc
    s_nop 1
    v_max_u32_dpp v14, v14, v14 quad_perm:[1,0,3,2] row_mask:0xf bank_mask:0xf
    s_nop 1
    v_max_u32_dpp v14, v14, v14 quad_perm:[2,3,0,1] row_mask:0xf bank_mask:0xf
    s_nop 1
    v_max_u32_dpp v14, v14, v14 row_half_mirror row_mask:0xf bank_mask:0xf
    s_nop 1
    v_max_u32_dpp v14, v14, v14 row_mirror row_mask:0xf bank_mask:0xf
    s_nop 0
    v_mov_b32 v13, v14
    s_nop 1
    v_permlane16_swap_b32 v14, v13
    s_nop 1
    v_max_u32 v14, v14, v13
    s_nop 0
    v_mov_b32 v13, v14
    s_nop 1
    v_permlane32_swap_b32 v14, v13
    s_nop 1
    v_max_u32 v14, v14, v13
    s_nop 0
    v_readfirstlane_b32 s49, v12
    v_readfirstlane_b32 s50, v14
    s_and_b32 s45, s49, 0x7ff
    s_sub_u32 s45, 2047, s45
    s_and_b32 s46, s50, 0x7ff
    s_sub_u32 s46, 2047, s46
    s_lshr_b32 s47, s45, 5
    s_lshr_b32 s48, s46, 5
    s_cmp_eq_u32 s47, s48
    s_cselect_b32 s32, 1, 0
    s_lshl_b32 s47, s47, 1
    s_lshl_b32 s48, s48, 1
    s_add_u32 s48, s48, s32
    v_lshlrev_b32 v6, 3, v0
    s_lshl_b32 s32, s47, 12
    s_add_u32 s32, s32, 262144
    v_add_u32 v7, s32, v6
    s_lshl_b32 s32, s48, 12
    s_add_u32 s32, s32, 262144
    v_add_u32 v8, s32, v6
    s_mov_b32 s64, 200000
L_poll_37:
    global_load_dwordx2 v[10:11], v7, s[24:25] sc1
    global_load_dwordx2 v[12:13], v8, s[24:25] sc1
    s_waitcnt vmcnt(0)
    v_cmp_ne_u32 vcc, s26, v11
    v_cmp_ne_u32 s[66:67], s26, v13
    s_or_b64 vcc, vcc, s[66:67]
    s_cbranch_vccz L_polld_38
    s_sub_u32 s64, s64, 1
    s_cbranch_scc0 L_poll_37
L_polld_38:
    v_lshlrev_b32 v6, 1, v0
    ds_write_b16 v6, v10 offset:32768
    ds_write_b16 v6, v12 offset:33792
    s_waitcnt lgkmcnt(0)
    s_barrier
    ds_read_b128 v[56:59], v64
    ds_read_b128 v[60:63], v64 offset:64
    s_waitcnt lgkmcnt(0)
    v_mfma_f32_16x16x32_bf16 v[32:35], v[56:59], v[40:43], v[32:35]
    v_mfma_f32_16x16x32_bf16 v[36:39], v[56:59], v[48:51], v[36:39]
    v_mfma_f32_16x16x32_bf16 v[32:35], v[60:63], v[44:47], v[32:35]
    v_mfma_f32_16x16x32_bf16 v[36:39], v[60:63], v[52:55], v[36:39]
    v_lshlrev_b32 v6, 4, v1
    s_lshl_b32 s32, s29, 8
    v_add_u32 v6, s32, v6
    s_nop 7
    v_mov_b32 v34, v36
    v_mov_b32 v35, v37
    s_mov_b64 exec, 0xffff
    ds_write_b128 v6, v[32:35] offset:36864
    s_mov_b64 exec, -1
    s_waitcnt lgkmcnt(0)
    s_barrier
    s_cmp_eq_u32 s29, 0
    s_cbranch_scc0 L_exit
    v_and_b32 v6, 15, v1
    v_lshlrev_b32 v6, 4, v6
    ds_read_b128 v[40:43], v6 offset:36864
    ds_read_b128 v[44:47], v6 offset:37120
    ds_read_b128 v[48:51], v6 offset:37376
    ds_read_b128 v[52:55], v6 offset:37632
    ds_read_b128 v[56:59], v6 offset:37888
    ds_read_b128 v[60:63], v6 offset:38144
    ds_read_b128 v[64:67], v6 offset:38400
    ds_read_b128 v[68:71], v6 offset:38656
    s_waitcnt lgkmcnt(0)
    v_add_f32 v40, v40, v44
    v_add_f32 v41, v41, v45
    v_add_f32 v42, v42, v46
    v_add_f32 v43, v43, v47
    v_add_f32 v40, v40, v48
    v_add_f32 v41, v41, v49
    v_add_f32 v42, v42, v50
    v_add_f32 v43, v43, v51
    v_add_f32 v40, v40, v52
    v_add_f32 v41, v41, v53
    v_add_f32 v42, v42, v54
    v_add_f32 v43, v43, v55
    v_add_f32 v40, v40, v56
    v_add_f32 v41, v41, v57
    v_add_f32 v42, v42, v58
    v_add_f32 v43, v43, v59
    v_add_f32 v40, v40, v60
    v_add_f32 v41, v41, v61
    v_add_f32 v42, v42, v62
    v_add_f32 v43, v43, v63
    v_add_f32 v40, v40, v64
    v_add_f32 v41, v41, v65
    v_add_f32 v42, v42, v66
    v_add_f32 v43, v43, v67
    v_add_f32 v40, v40, v68
    v_add_f32 v41, v41, v69
    v_add_f32 v42, v42, v70
    v_add_f32 v43, v43, v71
    v_cvt_pk_bf16_f32 v40, v40, v40
    v_and_b32 v40, 0xffff0000, v40
    v_cvt_pk_bf16_f32 v41, v41, v41
    v_and_b32 v41, 0xffff0000, v41
    v_cvt_pk_bf16_f32 v42, v42, v42
    v_and_b32 v42, 0xffff0000, v42
    v_cvt_pk_bf16_f32 v43, v43, v43
    v_and_b32 v43, 0xffff0000, v43
    v_mul_f32 v8, 0xbfb8aa3b, v40
    v_exp_f32 v8, v8
    s_nop 0
    v_add_f32 v8, 1.0, v8
    v_rcp_f32 v8, v8
    s_nop 0
    v_mul_f32 v40, v40, v8
    v_cvt_pk_bf16_f32 v40, v40, v40
    v_and_b32 v40, 0xffff0000, v40
    v_mul_f32 v9, 0xbfb8aa3b, v41
    v_exp_f32 v9, v9
    s_nop 0
    v_add_f32 v9, 1.0, v9
    v_rcp_f32 v9, v9
    s_nop 0
    v_mul_f32 v41, v41, v9
    v_cvt_pk_bf16_f32 v41, v41, v41
    v_and_b32 v41, 0xffff0000, v41
    v_mul_f32 v40, v40, v42
    v_mul_f32 v41, v41, v43
    v_cvt_pk_bf16_f32 v40, v40, v41
    v_mov_b32 v41, s26
    s_lshl_b32 s32, s56, 7
    s_add_u32 s32, s32, 229376
    v_lshrrev_b32 v6, 1, v6
    v_add_u32 v6, s32, v6
    s_mov_b64 exec, 0xffff
    global_store_dwordx2 v6, v[40:41], s[24:25] sc1
    s_waitcnt vmcnt(0)
    s_endpgm
L_exit:
    s_endpgm
.section .rodata,"a"
.p2align 6
.amdhsa_kernel adaLN_cond__sliding_block__moe_arch_mod__prompt_kernel
  .amdhsa_next_free_vgpr 256
  .amdhsa_next_free_sgpr 102
  .amdhsa_accum_offset 256
  .amdhsa_group_segment_fixed_size 0
  .amdhsa_kernarg_size 104
  .amdhsa_user_sgpr_count 2
  .amdhsa_user_sgpr_kernarg_segment_ptr 1
  .amdhsa_system_sgpr_workgroup_id_x 1
.end_amdhsa_kernel
```
